```python
import torch

def _softmax(x, axis=-1):
    return torch.softmax(x, dim=axis)
def _gelu(x):
    return torch.nn.functional.gelu(x, approximate="tanh")
def _silu(x):
    return torch.nn.functional.silu(x)
def _sigmoid(x):
    return torch.sigmoid(x)
def _layernorm(x, axis=-1, eps=1e-5):
    m = x.mean(dim=axis, keepdim=True)
    v = x.var(dim=axis, keepdim=True, unbiased=False)
    return (x - m) / torch.sqrt(v + eps)
def _scatter_add(tgt, idx, src, axis=0):
    return tgt.clone().index_add_(axis, idx, src)
def _segment_sum(src, seg, n):
    out = torch.zeros((n,) + src.shape[1:], dtype=src.dtype)
    return out.index_add_(0, seg, src)
def _pad(x, pw):
    flat = tuple(v for pair in reversed(pw) for v in pair)
    return torch.nn.functional.pad(x, flat)

kernel_name = 'parallel_sum__sliding_block__moe_arch_mod__prompt'

def setup_inputs():

    _w = (lambda a: (lambda t: t.to(torch.bfloat16) if t.is_floating_point() else t)(torch.as_tensor(a)))
    def _A_setup():
        B, S, D = 1, 2048, 448
        return {
            "x": _w((lambda *s: torch.randn(*s, dtype=torch.bfloat16) * 0.05)(B, S, D)),
            "wqkv": _w((lambda *s: torch.randn(*s, dtype=torch.bfloat16) * 0.05)(D, 3 * D)),
            "wo": _w((lambda *s: torch.randn(*s, dtype=torch.bfloat16) * 0.05)(D, D)),
        }
    _A_in = _A_setup()

    def _B_setup():
        B, S, D, F, C = 1, 2048, 448, 1792, 2
        return {
            "x": _w((lambda *s: torch.randn(*s, dtype=torch.bfloat16) * 0.05)(B, S, D)),
            "w_r": _w((lambda *s: torch.randn(*s, dtype=torch.bfloat16) * 0.05)(D)),
            "w_gate": _w((lambda *s: torch.randn(*s, dtype=torch.bfloat16) * 0.05)(D, F)),
            "w_up": _w((lambda *s: torch.randn(*s, dtype=torch.bfloat16) * 0.05)(D, F)),
            "w_down": _w((lambda *s: torch.randn(*s, dtype=torch.bfloat16) * 0.05)(F, D)),
        }
    _B_in = _B_setup()

    return {
        "A_x": _A_in["x"],
        "A_wqkv": _A_in["wqkv"],
        "A_wo": _A_in["wo"],
        "B_x": _B_in["x"],
        "B_w_r": _B_in["w_r"],
        "B_w_gate": _B_in["w_gate"],
        "B_w_up": _B_in["w_up"],
        "B_w_down": _B_in["w_down"],
    }

def reference(A_x, A_wqkv, A_wo, B_x, B_w_r, B_w_gate, B_w_up, B_w_down):
    def _A_ref(x, wqkv, wo):
        B, S, D = x.shape
        H = 16; Dh = D // H; W = 256
        qkv = (lambda x, *d: x.permute(*d))((x @ wqkv).reshape(B, S, 3, H, Dh), 2, 0, 3, 1, 4)
        q, k, v = qkv[0], qkv[1], qkv[2]
        scores = torch.einsum("bhqd,bhkd->bhqk", q, k) * (Dh ** -0.5)
        idx = torch.arange(S)
        mask = (idx[:, None] - idx[None, :] >= 0) & (idx[:, None] - idx[None, :] < W)
        scores = torch.where(mask[None, None], scores, -1e9)
        p = _softmax(scores, axis=-1)
        o = torch.einsum("bhqk,bhkd->bhqd", p, v)
        return (lambda x, *d: x.permute(*d))(o, 0, 2, 1, 3).reshape(B, S, D) @ wo

    def _B_ref(x, w_r, w_gate, w_up, w_down):
        B, S, D = x.shape
        C = 2
        r = x @ w_r
        idx = torch.argsort(-r, axis=-1)[:, :C]
        idx_e = (lambda x, n, axis: torch.repeat_interleave(x, n, dim=axis))(idx.reshape(B, C, 1), D, axis=2)
        x_sel = (lambda x, i, axis: torch.take_along_dim(x, i, dim=axis))(x, idx_e, axis=1)
        g = _silu(x_sel @ w_gate)
        u = x_sel @ w_up
        y = (g * u) @ w_down
        r_sel = _sigmoid((lambda x, i, axis: torch.take_along_dim(x, i, dim=axis))(r, idx, axis=1))
        y = y * r_sel.reshape(B, C, 1)
        b_off = (torch.arange(B) * S).reshape(B, 1)
        flat_idx = (idx + b_off).reshape(B * C)
        zero = (x * 0.0).reshape(B * S, D)
        upd = _scatter_add(zero, flat_idx, y.reshape(B * C, D), axis=0)
        return x + upd.reshape(B, S, D)

    x = A_x
    xn = _layernorm(x, axis=-1)
    return x + _A_ref(xn, A_wqkv, A_wo) + _B_ref(xn, B_w_r, B_w_gate, B_w_up, B_w_down)
```

```asm
; @launch kernel=k1_kernel grid=(256,1,1) block=(512,1,1) lds=163840
; @launch kernel=k2_kernel grid=(312,1,1) block=(512,1,1) lds=60416
; @launch kernel=k3_kernel grid=(224,1,1) block=(512,1,1) lds=115200
.amdgcn_target "amdgcn-amd-amdhsa--gfx950"
.text
.globl k1_kernel
.p2align 8
.type k1_kernel,@function
k1_kernel:
    s_cmp_ge_u32 s2, 256
    s_cbranch_scc1 K1_done
    s_cmp_ge_u32 s2, 224
    s_cbranch_scc1 K1_prefetch
    s_load_dwordx4 s[4:7], s[0:1], 0
    s_load_dwordx2 s[8:9], s[0:1], 32
    s_load_dwordx2 s[10:11], s[0:1], 80
    s_bfe_u32 s12, s2, 0x20001
    s_lshl_b32 s12, s12, 2
    s_bfe_u32 s13, s2, 0x20003
    s_add_u32 s12, s12, s13
    s_and_b32 s14, s2, 1
    s_mul_i32 s14, s14, 7
    s_lshr_b32 s13, s2, 5
    s_add_u32 s14, s14, s13
    v_and_b32 v1, 63, v0
    v_lshrrev_b32 v2, 6, v0
    v_and_b32 v3, 15, v0
    v_bfe_u32 v4, v0, 4, 2
    s_lshl_b32 s15, s12, 7
    v_lshlrev_b32 v5, 4, v2
    v_add3_u32 v5, v5, v3, s15
    v_readfirstlane_b32 s34, v2
    v_lshrrev_b32 v6, 3, v1
    v_and_b32 v7, 7, v1
    v_xor_b32 v7, v7, v6
    v_lshl_add_u32 v6, v2, 3, v6
    v_add_u32 v6, s15, v6
    v_mul_u32_u24 v6, 896, v6
    v_lshl_add_u32 v6, v7, 4, v6
    v_lshrrev_b32 v7, 4, v1
    v_bfe_u32 v8, v2, 1, 1
    v_lshl_add_u32 v8, v8, 2, v7
    v_bfe_u32 v9, v1, 1, 3
    v_xor_b32 v9, v9, v8
    v_lshl_add_u32 v7, v2, 2, v7
    v_mul_u32_u24 v7, 2688, v7
    v_lshl_add_u32 v7, v9, 5, v7
    v_and_b32 v8, 1, v1
    v_lshl_add_u32 v7, v8, 4, v7
    s_mul_i32 s32, s14, 192
    v_add_u32 v7, s32, v7
    v_cmp_gt_u32 vcc, 6, v9
    v_mov_b32 v8, 0x7fffff00
    s_nop 0
    v_cndmask_b32 v7, v8, v7, vcc
    s_waitcnt lgkmcnt(0)
    s_mov_b32 s16, s4
    s_and_b32 s17, s5, 0xffff
    s_mov_b32 s18, 1835008
    s_mov_b32 s19, 0x00020000
    s_mov_b32 s20, s6
    s_and_b32 s21, s7, 0xffff
    s_mov_b32 s22, 1204224
    s_mov_b32 s23, 0x00020000
    s_mov_b32 s24, s10
    s_and_b32 s25, s11, 0xffff
    s_mov_b32 s26, 8388608
    s_mov_b32 s27, 0x00020000
    s_mov_b32 s28, s8
    s_and_b32 s29, s9, 0xffff
    s_mov_b32 s30, 896
    s_mov_b32 s31, 0x00020000
    s_lshl_b32 s35, s34, 10
    s_mov_b32 s36, 0
    s_add_u32 s37, s35, 114688
    s_mov_b32 m0, s37
    s_nop 0
    buffer_load_dwordx4 v6, s[16:19], s36 offen lds
    s_mov_b32 s36, 57344
    s_add_u32 s37, s35, 122880
    s_mov_b32 m0, s37
    s_nop 0
    buffer_load_dwordx4 v6, s[16:19], s36 offen lds
    s_mov_b32 s36, 0
    s_add_u32 s37, s35, 0
    s_mov_b32 m0, s37
    s_nop 0
    buffer_load_dwordx4 v7, s[20:23], s36 offen lds
    s_mov_b32 s36, 86016
    s_add_u32 s37, s35, 8192
    s_mov_b32 m0, s37
    s_nop 0
    buffer_load_dwordx4 v7, s[20:23], s36 offen lds
    s_mov_b32 s36, 128
    s_add_u32 s37, s35, 131072
    s_mov_b32 m0, s37
    s_nop 0
    buffer_load_dwordx4 v6, s[16:19], s36 offen lds
    s_mov_b32 s36, 57472
    s_add_u32 s37, s35, 139264
    s_mov_b32 m0, s37
    s_nop 0
    buffer_load_dwordx4 v6, s[16:19], s36 offen lds
    s_mov_b32 s36, 172032
    s_add_u32 s37, s35, 16384
    s_mov_b32 m0, s37
    s_nop 0
    buffer_load_dwordx4 v7, s[20:23], s36 offen lds
    s_mov_b32 s36, 258048
    s_add_u32 s37, s35, 24576
    s_mov_b32 m0, s37
    s_nop 0
    buffer_load_dwordx4 v7, s[20:23], s36 offen lds
    s_mov_b32 s36, 256
    s_add_u32 s37, s35, 147456
    s_mov_b32 m0, s37
    s_nop 0
    buffer_load_dwordx4 v6, s[16:19], s36 offen lds
    s_mov_b32 s36, 57600
    s_add_u32 s37, s35, 155648
    s_mov_b32 m0, s37
    s_nop 0
    buffer_load_dwordx4 v6, s[16:19], s36 offen lds
    s_mov_b32 s36, 344064
    s_add_u32 s37, s35, 32768
    s_mov_b32 m0, s37
    s_nop 0
    buffer_load_dwordx4 v7, s[20:23], s36 offen lds
    s_mov_b32 s36, 430080
    s_add_u32 s37, s35, 40960
    s_mov_b32 m0, s37
    s_nop 0
    buffer_load_dwordx4 v7, s[20:23], s36 offen lds
    s_mov_b32 s36, 516096
    s_add_u32 s37, s35, 49152
    s_mov_b32 m0, s37
    s_nop 0
    buffer_load_dwordx4 v7, s[20:23], s36 offen lds
    s_mov_b32 s36, 602112
    s_add_u32 s37, s35, 57344
    s_mov_b32 m0, s37
    s_nop 0
    buffer_load_dwordx4 v7, s[20:23], s36 offen lds
    s_mov_b32 s36, 688128
    s_add_u32 s37, s35, 65536
    s_mov_b32 m0, s37
    s_nop 0
    buffer_load_dwordx4 v7, s[20:23], s36 offen lds
    s_mov_b32 s36, 774144
    s_add_u32 s37, s35, 73728
    s_mov_b32 m0, s37
    s_nop 0
    buffer_load_dwordx4 v7, s[20:23], s36 offen lds
    s_mov_b32 s36, 860160
    s_add_u32 s37, s35, 81920
    s_mov_b32 m0, s37
    s_nop 0
    buffer_load_dwordx4 v7, s[20:23], s36 offen lds
    s_mov_b32 s36, 946176
    s_add_u32 s37, s35, 90112
    s_mov_b32 m0, s37
    s_nop 0
    buffer_load_dwordx4 v7, s[20:23], s36 offen lds
    s_mov_b32 s36, 1032192
    s_add_u32 s37, s35, 98304
    s_mov_b32 m0, s37
    s_nop 0
    buffer_load_dwordx4 v7, s[20:23], s36 offen lds
    s_mov_b32 s36, 1118208
    s_add_u32 s37, s35, 106496
    s_mov_b32 m0, s37
    s_nop 0
    buffer_load_dwordx4 v7, s[20:23], s36 offen lds
    v_mov_b32 v12, 0x3f803f80
    v_mov_b32 v13, 0x3f803f80
    v_mov_b32 v14, 0x3f803f80
    v_mov_b32 v15, 0x3f803f80
    v_mov_b32 v200, 0
    v_mov_b32 v201, 0
    v_mov_b32 v202, 0
    v_mov_b32 v203, 0
    v_mov_b32 v204, 0
    v_mov_b32 v205, 0
    v_mov_b32 v206, 0
    v_mov_b32 v207, 0
    v_mov_b32 v208, 0
    v_mov_b32 v209, 0
    v_mov_b32 v210, 0
    v_mov_b32 v211, 0
    v_mov_b32 v212, 0
    v_mov_b32 v213, 0
    v_mov_b32 v214, 0
    v_mov_b32 v215, 0
    v_mov_b32 v216, 0
    v_mov_b32 v217, 0
    v_mov_b32 v218, 0
    v_mov_b32 v219, 0
    v_mov_b32 v220, 0
    v_mov_b32 v221, 0
    v_mov_b32 v222, 0
    v_mov_b32 v223, 0
    v_mov_b32 v224, 0
    v_mov_b32 v225, 0
    v_mov_b32 v226, 0
    v_mov_b32 v227, 0
    v_mov_b32 v228, 0
    v_mov_b32 v229, 0
    v_mov_b32 v230, 0
    v_mov_b32 v231, 0
    v_mov_b32 v232, 0
    v_mov_b32 v233, 0
    v_mov_b32 v234, 0
    v_mov_b32 v235, 0
    v_and_b32 v8, 7, v3
    v_xor_b32 v8, v8, v4
    v_lshlrev_b32 v8, 4, v8
    v_lshl_add_u32 v9, v2, 4, v3
    v_lshl_add_u32 v8, v9, 7, v8
    v_add_u32 v8, 114688, v8
    v_xor_b32 v9, 64, v8
    v_lshrrev_b32 v10, 2, v3
    v_and_b32 v11, 1, v4
    v_lshl_add_u32 v11, v11, 2, v10
    v_lshl_add_u32 v10, v4, 3, v10
    v_lshlrev_b32 v10, 8, v10
    v_and_b32 v16, 3, v3
    v_lshl_add_u32 v10, v16, 3, v10
    v_xor_b32 v16, 0, v11
    v_lshl_add_u32 v40, v16, 5, v10
    v_xor_b32 v16, 1, v11
    v_lshl_add_u32 v41, v16, 5, v10
    v_xor_b32 v16, 2, v11
    v_lshl_add_u32 v42, v16, 5, v10
    v_xor_b32 v16, 3, v11
    v_lshl_add_u32 v43, v16, 5, v10
    v_xor_b32 v16, 4, v11
    v_lshl_add_u32 v44, v16, 5, v10
    v_xor_b32 v16, 5, v11
    v_lshl_add_u32 v45, v16, 5, v10
    s_cmp_ge_u32 s34, 6
    s_cselect_b32 s38, 0, s34
    v_xor_b32 v16, s38, v11
    v_lshl_add_u32 v46, v16, 5, v10
    s_waitcnt vmcnt(16)
    s_barrier
    ds_read_b128 v[64:67], v8 offset:0
    ds_read_b128 v[68:71], v9 offset:0
    ds_read_b64_tr_b16 v[128:129], v40 offset:0
    ds_read_b64_tr_b16 v[130:131], v40 offset:1024
    ds_read_b64_tr_b16 v[132:133], v41 offset:0
    ds_read_b64_tr_b16 v[134:135], v41 offset:1024
    ds_read_b64_tr_b16 v[136:137], v42 offset:0
    ds_read_b64_tr_b16 v[138:139], v42 offset:1024
    ds_read_b64_tr_b16 v[140:141], v43 offset:0
    ds_read_b64_tr_b16 v[142:143], v43 offset:1024
    ds_read_b64_tr_b16 v[144:145], v44 offset:0
    ds_read_b64_tr_b16 v[146:147], v44 offset:1024
    ds_read_b64_tr_b16 v[148:149], v45 offset:0
    ds_read_b64_tr_b16 v[150:151], v45 offset:1024
    ds_read_b64_tr_b16 v[152:153], v46 offset:0
    ds_read_b64_tr_b16 v[154:155], v46 offset:1024
    s_waitcnt lgkmcnt(12)
    v_mfma_f32_16x16x32_bf16 v[200:203], v[128:131], v[64:67], v[200:203]
    ds_read_b64_tr_b16 v[160:161], v40 offset:8192
    ds_read_b64_tr_b16 v[162:163], v40 offset:9216
    s_waitcnt lgkmcnt(12)
    v_mfma_f32_16x16x32_bf16 v[204:207], v[132:135], v[64:67], v[204:207]
    ds_read_b64_tr_b16 v[164:165], v41 offset:8192
    ds_read_b64_tr_b16 v[166:167], v41 offset:9216
    s_waitcnt lgkmcnt(12)
    v_mfma_f32_16x16x32_bf16 v[208:211], v[136:139], v[64:67], v[208:211]
    ds_read_b64_tr_b16 v[168:169], v42 offset:8192
    ds_read_b64_tr_b16 v[170:171], v42 offset:9216
    s_waitcnt lgkmcnt(12)
    v_mfma_f32_16x16x32_bf16 v[212:215], v[140:143], v[64:67], v[212:215]
    ds_read_b64_tr_b16 v[172:173], v43 offset:8192
    ds_read_b64_tr_b16 v[174:175], v43 offset:9216
    s_waitcnt lgkmcnt(12)
    v_mfma_f32_16x16x32_bf16 v[216:219], v[144:147], v[64:67], v[216:219]
    ds_read_b64_tr_b16 v[176:177], v44 offset:8192
    ds_read_b64_tr_b16 v[178:179], v44 offset:9216
    s_waitcnt lgkmcnt(12)
    v_mfma_f32_16x16x32_bf16 v[220:223], v[148:151], v[64:67], v[220:223]
    ds_read_b64_tr_b16 v[180:181], v45 offset:8192
    ds_read_b64_tr_b16 v[182:183], v45 offset:9216
    s_waitcnt lgkmcnt(12)
    v_mfma_f32_16x16x32_bf16 v[232:235], v[152:155], v[12:15], v[232:235]
    ds_read_b64_tr_b16 v[184:185], v46 offset:8192
    ds_read_b64_tr_b16 v[186:187], v46 offset:9216
    v_mfma_f32_16x16x32_bf16 v[224:227], v[64:67], v[64:67], v[224:227]
    v_mfma_f32_16x16x32_bf16 v[228:231], v[64:67], v[12:15], v[228:231]
    s_waitcnt vmcnt(12)
    s_barrier
    s_mov_b32 s36, 384
    s_add_u32 s37, s35, 114688
    s_mov_b32 m0, s37
    s_nop 0
    buffer_load_dwordx4 v6, s[16:19], s36 offen lds
    s_mov_b32 s36, 57728
    s_add_u32 s37, s35, 122880
    s_mov_b32 m0, s37
    s_nop 0
    buffer_load_dwordx4 v6, s[16:19], s36 offen lds
    ds_read_b128 v[72:75], v8 offset:16384
    ds_read_b128 v[76:79], v9 offset:16384
    s_waitcnt lgkmcnt(12)
    v_mfma_f32_16x16x32_bf16 v[200:203], v[160:163], v[68:71], v[200:203]
    ds_read_b64_tr_b16 v[128:129], v40 offset:16384
    ds_read_b64_tr_b16 v[130:131], v40 offset:17408
    s_waitcnt lgkmcnt(12)
    v_mfma_f32_16x16x32_bf16 v[204:207], v[164:167], v[68:71], v[204:207]
    ds_read_b64_tr_b16 v[132:133], v41 offset:16384
    ds_read_b64_tr_b16 v[134:135], v41 offset:17408
    s_waitcnt lgkmcnt(12)
    v_mfma_f32_16x16x32_bf16 v[208:211], v[168:171], v[68:71], v[208:211]
    ds_read_b64_tr_b16 v[136:137], v42 offset:16384
    ds_read_b64_tr_b16 v[138:139], v42 offset:17408
    s_waitcnt lgkmcnt(12)
    v_mfma_f32_16x16x32_bf16 v[212:215], v[172:175], v[68:71], v[212:215]
    ds_read_b64_tr_b16 v[140:141], v43 offset:16384
    ds_read_b64_tr_b16 v[142:143], v43 offset:17408
    s_waitcnt lgkmcnt(12)
    v_mfma_f32_16x16x32_bf16 v[216:219], v[176:179], v[68:71], v[216:219]
    ds_read_b64_tr_b16 v[144:145], v44 offset:16384
    ds_read_b64_tr_b16 v[146:147], v44 offset:17408
    s_waitcnt lgkmcnt(12)
    v_mfma_f32_16x16x32_bf16 v[220:223], v[180:183], v[68:71], v[220:223]
    ds_read_b64_tr_b16 v[148:149], v45 offset:16384
    ds_read_b64_tr_b16 v[150:151], v45 offset:17408
    s_waitcnt lgkmcnt(12)
    v_mfma_f32_16x16x32_bf16 v[232:235], v[184:187], v[12:15], v[232:235]
    ds_read_b64_tr_b16 v[152:153], v46 offset:16384
    ds_read_b64_tr_b16 v[154:155], v46 offset:17408
    v_mfma_f32_16x16x32_bf16 v[224:227], v[68:71], v[68:71], v[224:227]
    v_mfma_f32_16x16x32_bf16 v[228:231], v[68:71], v[12:15], v[228:231]
    s_waitcnt lgkmcnt(12)
    v_mfma_f32_16x16x32_bf16 v[200:203], v[128:131], v[72:75], v[200:203]
    ds_read_b64_tr_b16 v[160:161], v40 offset:24576
    ds_read_b64_tr_b16 v[162:163], v40 offset:25600
    s_waitcnt lgkmcnt(12)
    v_mfma_f32_16x16x32_bf16 v[204:207], v[132:135], v[72:75], v[204:207]
    ds_read_b64_tr_b16 v[164:165], v41 offset:24576
    ds_read_b64_tr_b16 v[166:167], v41 offset:25600
    s_waitcnt lgkmcnt(12)
    v_mfma_f32_16x16x32_bf16 v[208:211], v[136:139], v[72:75], v[208:211]
    ds_read_b64_tr_b16 v[168:169], v42 offset:24576
    ds_read_b64_tr_b16 v[170:171], v42 offset:25600
    s_waitcnt lgkmcnt(12)
    v_mfma_f32_16x16x32_bf16 v[212:215], v[140:143], v[72:75], v[212:215]
    ds_read_b64_tr_b16 v[172:173], v43 offset:24576
    ds_read_b64_tr_b16 v[174:175], v43 offset:25600
    s_waitcnt lgkmcnt(12)
    v_mfma_f32_16x16x32_bf16 v[216:219], v[144:147], v[72:75], v[216:219]
    ds_read_b64_tr_b16 v[176:177], v44 offset:24576
    ds_read_b64_tr_b16 v[178:179], v44 offset:25600
    s_waitcnt lgkmcnt(12)
    v_mfma_f32_16x16x32_bf16 v[220:223], v[148:151], v[72:75], v[220:223]
    ds_read_b64_tr_b16 v[180:181], v45 offset:24576
    ds_read_b64_tr_b16 v[182:183], v45 offset:25600
    s_waitcnt lgkmcnt(12)
    v_mfma_f32_16x16x32_bf16 v[232:235], v[152:155], v[12:15], v[232:235]
    ds_read_b64_tr_b16 v[184:185], v46 offset:24576
    ds_read_b64_tr_b16 v[186:187], v46 offset:25600
    v_mfma_f32_16x16x32_bf16 v[224:227], v[72:75], v[72:75], v[224:227]
    v_mfma_f32_16x16x32_bf16 v[228:231], v[72:75], v[12:15], v[228:231]
    s_waitcnt vmcnt(10)
    s_barrier
    s_mov_b32 s36, 512
    s_add_u32 s37, s35, 131072
    s_mov_b32 m0, s37
    s_nop 0
    buffer_load_dwordx4 v6, s[16:19], s36 offen lds
    s_mov_b32 s36, 57856
    s_add_u32 s37, s35, 139264
    s_mov_b32 m0, s37
    s_nop 0
    buffer_load_dwordx4 v6, s[16:19], s36 offen lds
    ds_read_b128 v[80:83], v8 offset:32768
    ds_read_b128 v[84:87], v9 offset:32768
    s_waitcnt lgkmcnt(12)
    v_mfma_f32_16x16x32_bf16 v[200:203], v[160:163], v[76:79], v[200:203]
    ds_read_b64_tr_b16 v[128:129], v40 offset:32768
    ds_read_b64_tr_b16 v[130:131], v40 offset:33792
    s_waitcnt lgkmcnt(12)
    v_mfma_f32_16x16x32_bf16 v[204:207], v[164:167], v[76:79], v[204:207]
    ds_read_b64_tr_b16 v[132:133], v41 offset:32768
    ds_read_b64_tr_b16 v[134:135], v41 offset:33792
    s_waitcnt lgkmcnt(12)
    v_mfma_f32_16x16x32_bf16 v[208:211], v[168:171], v[76:79], v[208:211]
    ds_read_b64_tr_b16 v[136:137], v42 offset:32768
    ds_read_b64_tr_b16 v[138:139], v42 offset:33792
    s_waitcnt lgkmcnt(12)
    v_mfma_f32_16x16x32_bf16 v[212:215], v[172:175], v[76:79], v[212:215]
    ds_read_b64_tr_b16 v[140:141], v43 offset:32768
    ds_read_b64_tr_b16 v[142:143], v43 offset:33792
    s_waitcnt lgkmcnt(12)
    v_mfma_f32_16x16x32_bf16 v[216:219], v[176:179], v[76:79], v[216:219]
    ds_read_b64_tr_b16 v[144:145], v44 offset:32768
    ds_read_b64_tr_b16 v[146:147], v44 offset:33792
    s_waitcnt lgkmcnt(12)
    v_mfma_f32_16x16x32_bf16 v[220:223], v[180:183], v[76:79], v[220:223]
    ds_read_b64_tr_b16 v[148:149], v45 offset:32768
    ds_read_b64_tr_b16 v[150:151], v45 offset:33792
    s_waitcnt lgkmcnt(12)
    v_mfma_f32_16x16x32_bf16 v[232:235], v[184:187], v[12:15], v[232:235]
    ds_read_b64_tr_b16 v[152:153], v46 offset:32768
    ds_read_b64_tr_b16 v[154:155], v46 offset:33792
    v_mfma_f32_16x16x32_bf16 v[224:227], v[76:79], v[76:79], v[224:227]
    v_mfma_f32_16x16x32_bf16 v[228:231], v[76:79], v[12:15], v[228:231]
    s_waitcnt lgkmcnt(12)
    v_mfma_f32_16x16x32_bf16 v[200:203], v[128:131], v[80:83], v[200:203]
    ds_read_b64_tr_b16 v[160:161], v40 offset:40960
    ds_read_b64_tr_b16 v[162:163], v40 offset:41984
    s_waitcnt lgkmcnt(12)
    v_mfma_f32_16x16x32_bf16 v[204:207], v[132:135], v[80:83], v[204:207]
    ds_read_b64_tr_b16 v[164:165], v41 offset:40960
    ds_read_b64_tr_b16 v[166:167], v41 offset:41984
    s_waitcnt lgkmcnt(12)
    v_mfma_f32_16x16x32_bf16 v[208:211], v[136:139], v[80:83], v[208:211]
    ds_read_b64_tr_b16 v[168:169], v42 offset:40960
    ds_read_b64_tr_b16 v[170:171], v42 offset:41984
    s_waitcnt lgkmcnt(12)
    v_mfma_f32_16x16x32_bf16 v[212:215], v[140:143], v[80:83], v[212:215]
    ds_read_b64_tr_b16 v[172:173], v43 offset:40960
    ds_read_b64_tr_b16 v[174:175], v43 offset:41984
    s_waitcnt lgkmcnt(12)
    v_mfma_f32_16x16x32_bf16 v[216:219], v[144:147], v[80:83], v[216:219]
    ds_read_b64_tr_b16 v[176:177], v44 offset:40960
    ds_read_b64_tr_b16 v[178:179], v44 offset:41984
    s_waitcnt lgkmcnt(12)
    v_mfma_f32_16x16x32_bf16 v[220:223], v[148:151], v[80:83], v[220:223]
    ds_read_b64_tr_b16 v[180:181], v45 offset:40960
    ds_read_b64_tr_b16 v[182:183], v45 offset:41984
    s_waitcnt lgkmcnt(12)
    v_mfma_f32_16x16x32_bf16 v[232:235], v[152:155], v[12:15], v[232:235]
    ds_read_b64_tr_b16 v[184:185], v46 offset:40960
    ds_read_b64_tr_b16 v[186:187], v46 offset:41984
    v_mfma_f32_16x16x32_bf16 v[224:227], v[80:83], v[80:83], v[224:227]
    v_mfma_f32_16x16x32_bf16 v[228:231], v[80:83], v[12:15], v[228:231]
    s_waitcnt vmcnt(2)
    s_barrier
    s_mov_b32 s36, 640
    s_add_u32 s37, s35, 147456
    s_mov_b32 m0, s37
    s_nop 0
    buffer_load_dwordx4 v6, s[16:19], s36 offen lds
    s_mov_b32 s36, 57984
    s_add_u32 s37, s35, 155648
    s_mov_b32 m0, s37
    s_nop 0
    buffer_load_dwordx4 v6, s[16:19], s36 offen lds
    ds_read_b128 v[88:91], v8 offset:0
    ds_read_b128 v[92:95], v9 offset:0
    s_waitcnt lgkmcnt(12)
    v_mfma_f32_16x16x32_bf16 v[200:203], v[160:163], v[84:87], v[200:203]
    ds_read_b64_tr_b16 v[128:129], v40 offset:49152
    ds_read_b64_tr_b16 v[130:131], v40 offset:50176
    s_waitcnt lgkmcnt(12)
    v_mfma_f32_16x16x32_bf16 v[204:207], v[164:167], v[84:87], v[204:207]
    ds_read_b64_tr_b16 v[132:133], v41 offset:49152
    ds_read_b64_tr_b16 v[134:135], v41 offset:50176
    s_waitcnt lgkmcnt(12)
    v_mfma_f32_16x16x32_bf16 v[208:211], v[168:171], v[84:87], v[208:211]
    ds_read_b64_tr_b16 v[136:137], v42 offset:49152
    ds_read_b64_tr_b16 v[138:139], v42 offset:50176
    s_waitcnt lgkmcnt(12)
    v_mfma_f32_16x16x32_bf16 v[212:215], v[172:175], v[84:87], v[212:215]
    ds_read_b64_tr_b16 v[140:141], v43 offset:49152
    ds_read_b64_tr_b16 v[142:143], v43 offset:50176
    s_waitcnt lgkmcnt(12)
    v_mfma_f32_16x16x32_bf16 v[216:219], v[176:179], v[84:87], v[216:219]
    ds_read_b64_tr_b16 v[144:145], v44 offset:49152
    ds_read_b64_tr_b16 v[146:147], v44 offset:50176
    s_waitcnt lgkmcnt(12)
    v_mfma_f32_16x16x32_bf16 v[220:223], v[180:183], v[84:87], v[220:223]
    ds_read_b64_tr_b16 v[148:149], v45 offset:49152
    ds_read_b64_tr_b16 v[150:151], v45 offset:50176
    s_waitcnt lgkmcnt(12)
    v_mfma_f32_16x16x32_bf16 v[232:235], v[184:187], v[12:15], v[232:235]
    ds_read_b64_tr_b16 v[152:153], v46 offset:49152
    ds_read_b64_tr_b16 v[154:155], v46 offset:50176
    v_mfma_f32_16x16x32_bf16 v[224:227], v[84:87], v[84:87], v[224:227]
    v_mfma_f32_16x16x32_bf16 v[228:231], v[84:87], v[12:15], v[228:231]
    v_add_u32 v40, 57344, v40
    v_add_u32 v41, 57344, v41
    v_add_u32 v42, 57344, v42
    v_add_u32 v43, 57344, v43
    v_add_u32 v44, 57344, v44
    v_add_u32 v45, 57344, v45
    v_add_u32 v46, 57344, v46
    s_waitcnt lgkmcnt(12)
    v_mfma_f32_16x16x32_bf16 v[200:203], v[128:131], v[88:91], v[200:203]
    ds_read_b64_tr_b16 v[160:161], v40 offset:0
    ds_read_b64_tr_b16 v[162:163], v40 offset:1024
    s_waitcnt lgkmcnt(12)
    v_mfma_f32_16x16x32_bf16 v[204:207], v[132:135], v[88:91], v[204:207]
    ds_read_b64_tr_b16 v[164:165], v41 offset:0
    ds_read_b64_tr_b16 v[166:167], v41 offset:1024
    s_waitcnt lgkmcnt(12)
    v_mfma_f32_16x16x32_bf16 v[208:211], v[136:139], v[88:91], v[208:211]
    ds_read_b64_tr_b16 v[168:169], v42 offset:0
    ds_read_b64_tr_b16 v[170:171], v42 offset:1024
    s_waitcnt lgkmcnt(12)
    v_mfma_f32_16x16x32_bf16 v[212:215], v[140:143], v[88:91], v[212:215]
    ds_read_b64_tr_b16 v[172:173], v43 offset:0
    ds_read_b64_tr_b16 v[174:175], v43 offset:1024
    s_waitcnt lgkmcnt(12)
    v_mfma_f32_16x16x32_bf16 v[216:219], v[144:147], v[88:91], v[216:219]
    ds_read_b64_tr_b16 v[176:177], v44 offset:0
    ds_read_b64_tr_b16 v[178:179], v44 offset:1024
    s_waitcnt lgkmcnt(12)
    v_mfma_f32_16x16x32_bf16 v[220:223], v[148:151], v[88:91], v[220:223]
    ds_read_b64_tr_b16 v[180:181], v45 offset:0
    ds_read_b64_tr_b16 v[182:183], v45 offset:1024
    s_waitcnt lgkmcnt(12)
    v_mfma_f32_16x16x32_bf16 v[232:235], v[152:155], v[12:15], v[232:235]
    ds_read_b64_tr_b16 v[184:185], v46 offset:0
    ds_read_b64_tr_b16 v[186:187], v46 offset:1024
    v_mfma_f32_16x16x32_bf16 v[224:227], v[88:91], v[88:91], v[224:227]
    v_mfma_f32_16x16x32_bf16 v[228:231], v[88:91], v[12:15], v[228:231]
    s_waitcnt vmcnt(2)
    s_barrier
    s_mov_b32 s36, 768
    s_add_u32 s37, s35, 114688
    s_mov_b32 m0, s37
    s_nop 0
    buffer_load_dwordx4 v6, s[16:19], s36 offen lds
    s_mov_b32 s36, 58112
    s_add_u32 s37, s35, 122880
    s_mov_b32 m0, s37
    s_nop 0
    buffer_load_dwordx4 v6, s[16:19], s36 offen lds
    ds_read_b128 v[96:99], v8 offset:16384
    ds_read_b128 v[100:103], v9 offset:16384
    s_waitcnt lgkmcnt(12)
    v_mfma_f32_16x16x32_bf16 v[200:203], v[160:163], v[92:95], v[200:203]
    ds_read_b64_tr_b16 v[128:129], v40 offset:8192
    ds_read_b64_tr_b16 v[130:131], v40 offset:9216
    s_waitcnt lgkmcnt(12)
    v_mfma_f32_16x16x32_bf16 v[204:207], v[164:167], v[92:95], v[204:207]
    ds_read_b64_tr_b16 v[132:133], v41 offset:8192
    ds_read_b64_tr_b16 v[134:135], v41 offset:9216
    s_waitcnt lgkmcnt(12)
    v_mfma_f32_16x16x32_bf16 v[208:211], v[168:171], v[92:95], v[208:211]
    ds_read_b64_tr_b16 v[136:137], v42 offset:8192
    ds_read_b64_tr_b16 v[138:139], v42 offset:9216
    s_waitcnt lgkmcnt(12)
    v_mfma_f32_16x16x32_bf16 v[212:215], v[172:175], v[92:95], v[212:215]
    ds_read_b64_tr_b16 v[140:141], v43 offset:8192
    ds_read_b64_tr_b16 v[142:143], v43 offset:9216
    s_waitcnt lgkmcnt(12)
    v_mfma_f32_16x16x32_bf16 v[216:219], v[176:179], v[92:95], v[216:219]
    ds_read_b64_tr_b16 v[144:145], v44 offset:8192
    ds_read_b64_tr_b16 v[146:147], v44 offset:9216
    s_waitcnt lgkmcnt(12)
    v_mfma_f32_16x16x32_bf16 v[220:223], v[180:183], v[92:95], v[220:223]
    ds_read_b64_tr_b16 v[148:149], v45 offset:8192
    ds_read_b64_tr_b16 v[150:151], v45 offset:9216
    s_waitcnt lgkmcnt(12)
    v_mfma_f32_16x16x32_bf16 v[232:235], v[184:187], v[12:15], v[232:235]
    ds_read_b64_tr_b16 v[152:153], v46 offset:8192
    ds_read_b64_tr_b16 v[154:155], v46 offset:9216
    v_mfma_f32_16x16x32_bf16 v[224:227], v[92:95], v[92:95], v[224:227]
    v_mfma_f32_16x16x32_bf16 v[228:231], v[92:95], v[12:15], v[228:231]
    s_waitcnt lgkmcnt(12)
    v_mfma_f32_16x16x32_bf16 v[200:203], v[128:131], v[96:99], v[200:203]
    ds_read_b64_tr_b16 v[160:161], v40 offset:16384
    ds_read_b64_tr_b16 v[162:163], v40 offset:17408
    s_waitcnt lgkmcnt(12)
    v_mfma_f32_16x16x32_bf16 v[204:207], v[132:135], v[96:99], v[204:207]
    ds_read_b64_tr_b16 v[164:165], v41 offset:16384
    ds_read_b64_tr_b16 v[166:167], v41 offset:17408
    s_waitcnt lgkmcnt(12)
    v_mfma_f32_16x16x32_bf16 v[208:211], v[136:139], v[96:99], v[208:211]
    ds_read_b64_tr_b16 v[168:169], v42 offset:16384
    ds_read_b64_tr_b16 v[170:171], v42 offset:17408
    s_waitcnt lgkmcnt(12)
    v_mfma_f32_16x16x32_bf16 v[212:215], v[140:143], v[96:99], v[212:215]
    ds_read_b64_tr_b16 v[172:173], v43 offset:16384
    ds_read_b64_tr_b16 v[174:175], v43 offset:17408
    s_waitcnt lgkmcnt(12)
    v_mfma_f32_16x16x32_bf16 v[216:219], v[144:147], v[96:99], v[216:219]
    ds_read_b64_tr_b16 v[176:177], v44 offset:16384
    ds_read_b64_tr_b16 v[178:179], v44 offset:17408
    s_waitcnt lgkmcnt(12)
    v_mfma_f32_16x16x32_bf16 v[220:223], v[148:151], v[96:99], v[220:223]
    ds_read_b64_tr_b16 v[180:181], v45 offset:16384
    ds_read_b64_tr_b16 v[182:183], v45 offset:17408
    s_waitcnt lgkmcnt(12)
    v_mfma_f32_16x16x32_bf16 v[232:235], v[152:155], v[12:15], v[232:235]
    ds_read_b64_tr_b16 v[184:185], v46 offset:16384
    ds_read_b64_tr_b16 v[186:187], v46 offset:17408
    v_mfma_f32_16x16x32_bf16 v[224:227], v[96:99], v[96:99], v[224:227]
    v_mfma_f32_16x16x32_bf16 v[228:231], v[96:99], v[12:15], v[228:231]
    s_waitcnt vmcnt(2)
    s_barrier
    ds_read_b128 v[104:107], v8 offset:32768
    ds_read_b128 v[108:111], v9 offset:32768
    s_waitcnt lgkmcnt(12)
    v_mfma_f32_16x16x32_bf16 v[200:203], v[160:163], v[100:103], v[200:203]
    ds_read_b64_tr_b16 v[128:129], v40 offset:24576
    ds_read_b64_tr_b16 v[130:131], v40 offset:25600
    s_waitcnt lgkmcnt(12)
    v_mfma_f32_16x16x32_bf16 v[204:207], v[164:167], v[100:103], v[204:207]
    ds_read_b64_tr_b16 v[132:133], v41 offset:24576
    ds_read_b64_tr_b16 v[134:135], v41 offset:25600
    s_waitcnt lgkmcnt(12)
    v_mfma_f32_16x16x32_bf16 v[208:211], v[168:171], v[100:103], v[208:211]
    ds_read_b64_tr_b16 v[136:137], v42 offset:24576
    ds_read_b64_tr_b16 v[138:139], v42 offset:25600
    s_waitcnt lgkmcnt(12)
    v_mfma_f32_16x16x32_bf16 v[212:215], v[172:175], v[100:103], v[212:215]
    ds_read_b64_tr_b16 v[140:141], v43 offset:24576
    ds_read_b64_tr_b16 v[142:143], v43 offset:25600
    s_waitcnt lgkmcnt(12)
    v_mfma_f32_16x16x32_bf16 v[216:219], v[176:179], v[100:103], v[216:219]
    ds_read_b64_tr_b16 v[144:145], v44 offset:24576
    ds_read_b64_tr_b16 v[146:147], v44 offset:25600
    s_waitcnt lgkmcnt(12)
    v_mfma_f32_16x16x32_bf16 v[220:223], v[180:183], v[100:103], v[220:223]
    ds_read_b64_tr_b16 v[148:149], v45 offset:24576
    ds_read_b64_tr_b16 v[150:151], v45 offset:25600
    s_waitcnt lgkmcnt(12)
    v_mfma_f32_16x16x32_bf16 v[232:235], v[184:187], v[12:15], v[232:235]
    ds_read_b64_tr_b16 v[152:153], v46 offset:24576
    ds_read_b64_tr_b16 v[154:155], v46 offset:25600
    v_mfma_f32_16x16x32_bf16 v[224:227], v[100:103], v[100:103], v[224:227]
    v_mfma_f32_16x16x32_bf16 v[228:231], v[100:103], v[12:15], v[228:231]
    s_waitcnt lgkmcnt(12)
    v_mfma_f32_16x16x32_bf16 v[200:203], v[128:131], v[104:107], v[200:203]
    ds_read_b64_tr_b16 v[160:161], v40 offset:32768
    ds_read_b64_tr_b16 v[162:163], v40 offset:33792
    s_waitcnt lgkmcnt(12)
    v_mfma_f32_16x16x32_bf16 v[204:207], v[132:135], v[104:107], v[204:207]
    ds_read_b64_tr_b16 v[164:165], v41 offset:32768
    ds_read_b64_tr_b16 v[166:167], v41 offset:33792
    s_waitcnt lgkmcnt(12)
    v_mfma_f32_16x16x32_bf16 v[208:211], v[136:139], v[104:107], v[208:211]
    ds_read_b64_tr_b16 v[168:169], v42 offset:32768
    ds_read_b64_tr_b16 v[170:171], v42 offset:33792
    s_waitcnt lgkmcnt(12)
    v_mfma_f32_16x16x32_bf16 v[212:215], v[140:143], v[104:107], v[212:215]
    ds_read_b64_tr_b16 v[172:173], v43 offset:32768
    ds_read_b64_tr_b16 v[174:175], v43 offset:33792
    s_waitcnt lgkmcnt(12)
    v_mfma_f32_16x16x32_bf16 v[216:219], v[144:147], v[104:107], v[216:219]
    ds_read_b64_tr_b16 v[176:177], v44 offset:32768
    ds_read_b64_tr_b16 v[178:179], v44 offset:33792
    s_waitcnt lgkmcnt(12)
    v_mfma_f32_16x16x32_bf16 v[220:223], v[148:151], v[104:107], v[220:223]
    ds_read_b64_tr_b16 v[180:181], v45 offset:32768
    ds_read_b64_tr_b16 v[182:183], v45 offset:33792
    s_waitcnt lgkmcnt(12)
    v_mfma_f32_16x16x32_bf16 v[232:235], v[152:155], v[12:15], v[232:235]
    ds_read_b64_tr_b16 v[184:185], v46 offset:32768
    ds_read_b64_tr_b16 v[186:187], v46 offset:33792
    v_mfma_f32_16x16x32_bf16 v[224:227], v[104:107], v[104:107], v[224:227]
    v_mfma_f32_16x16x32_bf16 v[228:231], v[104:107], v[12:15], v[228:231]
    s_waitcnt vmcnt(0)
    s_barrier
    ds_read_b128 v[112:115], v8 offset:0
    ds_read_b128 v[116:119], v9 offset:0
    s_waitcnt lgkmcnt(12)
    v_mfma_f32_16x16x32_bf16 v[200:203], v[160:163], v[108:111], v[200:203]
    ds_read_b64_tr_b16 v[128:129], v40 offset:40960
    ds_read_b64_tr_b16 v[130:131], v40 offset:41984
    s_waitcnt lgkmcnt(12)
    v_mfma_f32_16x16x32_bf16 v[204:207], v[164:167], v[108:111], v[204:207]
    ds_read_b64_tr_b16 v[132:133], v41 offset:40960
    ds_read_b64_tr_b16 v[134:135], v41 offset:41984
    s_waitcnt lgkmcnt(12)
    v_mfma_f32_16x16x32_bf16 v[208:211], v[168:171], v[108:111], v[208:211]
    ds_read_b64_tr_b16 v[136:137], v42 offset:40960
    ds_read_b64_tr_b16 v[138:139], v42 offset:41984
    s_waitcnt lgkmcnt(12)
    v_mfma_f32_16x16x32_bf16 v[212:215], v[172:175], v[108:111], v[212:215]
    ds_read_b64_tr_b16 v[140:141], v43 offset:40960
    ds_read_b64_tr_b16 v[142:143], v43 offset:41984
    s_waitcnt lgkmcnt(12)
    v_mfma_f32_16x16x32_bf16 v[216:219], v[176:179], v[108:111], v[216:219]
    ds_read_b64_tr_b16 v[144:145], v44 offset:40960
    ds_read_b64_tr_b16 v[146:147], v44 offset:41984
    s_waitcnt lgkmcnt(12)
    v_mfma_f32_16x16x32_bf16 v[220:223], v[180:183], v[108:111], v[220:223]
    ds_read_b64_tr_b16 v[148:149], v45 offset:40960
    ds_read_b64_tr_b16 v[150:151], v45 offset:41984
    s_waitcnt lgkmcnt(12)
    v_mfma_f32_16x16x32_bf16 v[232:235], v[184:187], v[12:15], v[232:235]
    ds_read_b64_tr_b16 v[152:153], v46 offset:40960
    ds_read_b64_tr_b16 v[154:155], v46 offset:41984
    v_mfma_f32_16x16x32_bf16 v[224:227], v[108:111], v[108:111], v[224:227]
    v_mfma_f32_16x16x32_bf16 v[228:231], v[108:111], v[12:15], v[228:231]
    s_waitcnt lgkmcnt(12)
    v_mfma_f32_16x16x32_bf16 v[200:203], v[128:131], v[112:115], v[200:203]
    ds_read_b64_tr_b16 v[160:161], v40 offset:49152
    ds_read_b64_tr_b16 v[162:163], v40 offset:50176
    s_waitcnt lgkmcnt(12)
    v_mfma_f32_16x16x32_bf16 v[204:207], v[132:135], v[112:115], v[204:207]
    ds_read_b64_tr_b16 v[164:165], v41 offset:49152
    ds_read_b64_tr_b16 v[166:167], v41 offset:50176
    s_waitcnt lgkmcnt(12)
    v_mfma_f32_16x16x32_bf16 v[208:211], v[136:139], v[112:115], v[208:211]
    ds_read_b64_tr_b16 v[168:169], v42 offset:49152
    ds_read_b64_tr_b16 v[170:171], v42 offset:50176
    s_waitcnt lgkmcnt(12)
    v_mfma_f32_16x16x32_bf16 v[212:215], v[140:143], v[112:115], v[212:215]
    ds_read_b64_tr_b16 v[172:173], v43 offset:49152
    ds_read_b64_tr_b16 v[174:175], v43 offset:50176
    s_waitcnt lgkmcnt(12)
    v_mfma_f32_16x16x32_bf16 v[216:219], v[144:147], v[112:115], v[216:219]
    ds_read_b64_tr_b16 v[176:177], v44 offset:49152
    ds_read_b64_tr_b16 v[178:179], v44 offset:50176
    s_waitcnt lgkmcnt(12)
    v_mfma_f32_16x16x32_bf16 v[220:223], v[148:151], v[112:115], v[220:223]
    ds_read_b64_tr_b16 v[180:181], v45 offset:49152
    ds_read_b64_tr_b16 v[182:183], v45 offset:50176
    s_waitcnt lgkmcnt(12)
    v_mfma_f32_16x16x32_bf16 v[232:235], v[152:155], v[12:15], v[232:235]
    ds_read_b64_tr_b16 v[184:185], v46 offset:49152
    ds_read_b64_tr_b16 v[186:187], v46 offset:50176
    v_mfma_f32_16x16x32_bf16 v[224:227], v[112:115], v[112:115], v[224:227]
    v_mfma_f32_16x16x32_bf16 v[228:231], v[112:115], v[12:15], v[228:231]
    s_waitcnt lgkmcnt(0)
    v_mfma_f32_16x16x32_bf16 v[200:203], v[160:163], v[116:119], v[200:203]
    v_mfma_f32_16x16x32_bf16 v[204:207], v[164:167], v[116:119], v[204:207]
    v_mfma_f32_16x16x32_bf16 v[208:211], v[168:171], v[116:119], v[208:211]
    v_mfma_f32_16x16x32_bf16 v[212:215], v[172:175], v[116:119], v[212:215]
    v_mfma_f32_16x16x32_bf16 v[216:219], v[176:179], v[116:119], v[216:219]
    v_mfma_f32_16x16x32_bf16 v[220:223], v[180:183], v[116:119], v[220:223]
    v_mfma_f32_16x16x32_bf16 v[232:235], v[184:187], v[12:15], v[232:235]
    v_mfma_f32_16x16x32_bf16 v[224:227], v[116:119], v[116:119], v[224:227]
    v_mfma_f32_16x16x32_bf16 v[228:231], v[116:119], v[12:15], v[228:231]
    s_nop 15
    s_barrier
    s_cmp_ge_u32 s34, 6
    s_cbranch_scc1 K1_nocs
    v_cmp_eq_u32 vcc, 0, v3
    s_and_saveexec_b64 s[36:37], vcc
    v_lshlrev_b32 v7, 4, v4
    s_lshl_b32 s35, s34, 6
    v_add_u32 v7, s35, v7
    v_add_u32 v7, 114688, v7
    ds_write_b128 v7, v[232:235]
    s_mov_b64 exec, s[36:37]
K1_nocs:
    v_and_b32 v24, 3, v3
    v_cmp_eq_u32 vcc, 1, v24
    s_nop 1
    v_cndmask_b32 v25, v224, v225, vcc
    v_cndmask_b32 v26, v228, v229, vcc
    v_cmp_eq_u32 vcc, 2, v24
    s_nop 1
    v_cndmask_b32 v25, v25, v226, vcc
    v_cndmask_b32 v26, v26, v230, vcc
    v_cmp_eq_u32 vcc, 3, v24
    s_nop 1
    v_cndmask_b32 v25, v25, v227, vcc
    v_cndmask_b32 v26, v26, v231, vcc
    v_lshrrev_b32 v27, 2, v3
    v_lshl_add_u32 v27, v27, 4, v3
    v_lshlrev_b32 v27, 2, v27
    ds_bpermute_b32 v25, v27, v25
    ds_bpermute_b32 v26, v27, v26
    s_waitcnt lgkmcnt(0)
    s_barrier
    v_mov_b32 v28, 0x3b124925
    v_mul_f32 v26, v26, v28
    v_mul_f32 v25, v25, v28
    v_fma_f32 v25, -v26, v26, v25
    v_max_f32 v25, 0, v25
    v_cvt_pk_bf16_f32 v26, v26, v26
    v_lshlrev_b32 v26, 16, v26
    v_cvt_pk_bf16_f32 v25, v25, v25
    v_lshlrev_b32 v25, 16, v25
    v_add_f32 v25, 0x3727c5ac, v25
    v_cvt_pk_bf16_f32 v25, v25, v25
    v_lshlrev_b32 v25, 16, v25
    v_sqrt_f32 v25, v25
    s_nop 0
    v_cvt_pk_bf16_f32 v25, v25, v25
    v_lshlrev_b32 v25, 16, v25
    v_rcp_f32 v29, v25
    s_cmp_lg_u32 s14, 0
    s_cbranch_scc1 K1_nostats
    v_cmp_eq_u32 vcc, 0, v4
    s_and_saveexec_b64 s[36:37], vcc
    v_mov_b32 v30, v26
    v_mov_b32 v31, v25
    v_lshlrev_b32 v32, 3, v5
    v_add_u32 v32, 8126464, v32
    buffer_store_dwordx2 v[30:31], v32, s[24:27], 0 offen
    s_mov_b64 exec, s[36:37]
    v_lshlrev_b32 v38, 4, v4
    buffer_load_dwordx4 v[128:131], v38, s[28:31], 0 offen offset:0
    buffer_load_dwordx4 v[132:135], v38, s[28:31], 0 offen offset:64
    buffer_load_dwordx4 v[136:139], v38, s[28:31], 0 offen offset:128
    buffer_load_dwordx4 v[140:143], v38, s[28:31], 0 offen offset:192
    buffer_load_dwordx4 v[144:147], v38, s[28:31], 0 offen offset:256
    buffer_load_dwordx4 v[148:151], v38, s[28:31], 0 offen offset:320
    buffer_load_dwordx4 v[152:155], v38, s[28:31], 0 offen offset:384
    buffer_load_dwordx4 v[156:159], v38, s[28:31], 0 offen offset:448
    buffer_load_dwordx4 v[160:163], v38, s[28:31], 0 offen offset:512
    buffer_load_dwordx4 v[164:167], v38, s[28:31], 0 offen offset:576
    buffer_load_dwordx4 v[168:171], v38, s[28:31], 0 offen offset:640
    buffer_load_dwordx4 v[172:175], v38, s[28:31], 0 offen offset:704
    buffer_load_dwordx4 v[176:179], v38, s[28:31], 0 offen offset:768
    buffer_load_dwordx4 v[180:183], v38, s[28:31], 0 offen offset:832
    v_mov_b32 v40, 0
    v_mov_b32 v41, 0
    v_mov_b32 v42, 0
    v_mov_b32 v43, 0
    v_mov_b32 v232, 0
    v_mov_b32 v233, 0
    v_mov_b32 v234, 0
    v_mov_b32 v235, 0
    s_waitcnt vmcnt(0)
    v_mfma_f32_16x16x32_bf16 v[40:43], v[64:67], v[128:131], v[40:43]
    v_mfma_f32_16x16x32_bf16 v[232:235], v[12:15], v[128:131], v[232:235]
    v_mfma_f32_16x16x32_bf16 v[40:43], v[68:71], v[132:135], v[40:43]
    v_mfma_f32_16x16x32_bf16 v[232:235], v[12:15], v[132:135], v[232:235]
    v_mfma_f32_16x16x32_bf16 v[40:43], v[72:75], v[136:139], v[40:43]
    v_mfma_f32_16x16x32_bf16 v[232:235], v[12:15], v[136:139], v[232:235]
    v_mfma_f32_16x16x32_bf16 v[40:43], v[76:79], v[140:143], v[40:43]
    v_mfma_f32_16x16x32_bf16 v[232:235], v[12:15], v[140:143], v[232:235]
    v_mfma_f32_16x16x32_bf16 v[40:43], v[80:83], v[144:147], v[40:43]
    v_mfma_f32_16x16x32_bf16 v[232:235], v[12:15], v[144:147], v[232:235]
    v_mfma_f32_16x16x32_bf16 v[40:43], v[84:87], v[148:151], v[40:43]
    v_mfma_f32_16x16x32_bf16 v[232:235], v[12:15], v[148:151], v[232:235]
    v_mfma_f32_16x16x32_bf16 v[40:43], v[88:91], v[152:155], v[40:43]
    v_mfma_f32_16x16x32_bf16 v[232:235], v[12:15], v[152:155], v[232:235]
    v_mfma_f32_16x16x32_bf16 v[40:43], v[92:95], v[156:159], v[40:43]
    v_mfma_f32_16x16x32_bf16 v[232:235], v[12:15], v[156:159], v[232:235]
    v_mfma_f32_16x16x32_bf16 v[40:43], v[96:99], v[160:163], v[40:43]
    v_mfma_f32_16x16x32_bf16 v[232:235], v[12:15], v[160:163], v[232:235]
    v_mfma_f32_16x16x32_bf16 v[40:43], v[100:103], v[164:167], v[40:43]
    v_mfma_f32_16x16x32_bf16 v[232:235], v[12:15], v[164:167], v[232:235]
    v_mfma_f32_16x16x32_bf16 v[40:43], v[104:107], v[168:171], v[40:43]
    v_mfma_f32_16x16x32_bf16 v[232:235], v[12:15], v[168:171], v[232:235]
    v_mfma_f32_16x16x32_bf16 v[40:43], v[108:111], v[172:175], v[40:43]
    v_mfma_f32_16x16x32_bf16 v[232:235], v[12:15], v[172:175], v[232:235]
    v_mfma_f32_16x16x32_bf16 v[40:43], v[112:115], v[176:179], v[40:43]
    v_mfma_f32_16x16x32_bf16 v[232:235], v[12:15], v[176:179], v[232:235]
    v_mfma_f32_16x16x32_bf16 v[40:43], v[116:119], v[180:183], v[40:43]
    v_mfma_f32_16x16x32_bf16 v[232:235], v[12:15], v[180:183], v[232:235]
    s_nop 15
    v_lshlrev_b32 v33, 4, v4
    v_add_u32 v33, 0, v33
    ds_bpermute_b32 v46, v33, v26
    ds_bpermute_b32 v50, v33, v29
    v_lshlrev_b32 v33, 4, v4
    v_add_u32 v33, 4, v33
    ds_bpermute_b32 v47, v33, v26
    ds_bpermute_b32 v51, v33, v29
    v_lshlrev_b32 v33, 4, v4
    v_add_u32 v33, 8, v33
    ds_bpermute_b32 v48, v33, v26
    ds_bpermute_b32 v52, v33, v29
    v_lshlrev_b32 v33, 4, v4
    v_add_u32 v33, 12, v33
    ds_bpermute_b32 v49, v33, v26
    ds_bpermute_b32 v53, v33, v29
    s_waitcnt lgkmcnt(0)
    v_fma_f32 v40, -v46, v232, v40
    v_mul_f32 v40, v40, v50
    v_cvt_pk_bf16_f32 v40, v40, v40
    v_lshlrev_b32 v40, 16, v40
    v_fma_f32 v41, -v47, v232, v41
    v_mul_f32 v41, v41, v51
    v_cvt_pk_bf16_f32 v41, v41, v41
    v_lshlrev_b32 v41, 16, v41
    v_fma_f32 v42, -v48, v232, v42
    v_mul_f32 v42, v42, v52
    v_cvt_pk_bf16_f32 v42, v42, v42
    v_lshlrev_b32 v42, 16, v42
    v_fma_f32 v43, -v49, v232, v43
    v_mul_f32 v43, v43, v53
    v_cvt_pk_bf16_f32 v43, v43, v43
    v_lshlrev_b32 v43, 16, v43
    v_cmp_eq_u32 vcc, 0, v3
    s_and_saveexec_b64 s[36:37], vcc
    v_lshlrev_b32 v38, 4, v2
    v_lshl_add_u32 v38, v4, 2, v38
    v_add_u32 v38, s15, v38
    v_lshlrev_b32 v38, 2, v38
    v_add_u32 v38, 8142848, v38
    buffer_store_dwordx4 v[40:43], v38, s[24:27], 0 offen
    s_mov_b64 exec, s[36:37]
K1_nostats:
    v_lshlrev_b32 v7, 4, v4
    v_add_u32 v7, 114688, v7
    ds_read_b128 v[128:131], v7 offset:0
    ds_read_b128 v[132:135], v7 offset:64
    ds_read_b128 v[136:139], v7 offset:128
    ds_read_b128 v[140:143], v7 offset:192
    ds_read_b128 v[144:147], v7 offset:256
    ds_read_b128 v[148:151], v7 offset:320
    s_mul_i32 s35, s14, 24
    v_add_u32 v46, s35, v4
    s_movk_i32 s38, 9363
    v_sub_f32 v26, 0, v26
    s_waitcnt lgkmcnt(0)
    v_add_u32 v47, 0, v46
    v_mul_u32_u24 v48, s38, v47
    v_lshrrev_b32 v48, 16, v48
    v_mul_u32_u24 v49, 7, v48
    v_sub_u32 v49, v47, v49
    v_lshl_add_u32 v48, v48, 11, v5
    v_lshlrev_b32 v48, 6, v48
    v_lshl_add_u32 v48, v49, 3, v48
    v_fma_f32 v200, v26, v128, v200
    v_mul_f32 v200, v200, v29
    v_fma_f32 v201, v26, v129, v201
    v_mul_f32 v201, v201, v29
    v_fma_f32 v202, v26, v130, v202
    v_mul_f32 v202, v202, v29
    v_fma_f32 v203, v26, v131, v203
    v_mul_f32 v203, v203, v29
    v_cvt_pk_bf16_f32 v50, v200, v201
    v_cvt_pk_bf16_f32 v51, v202, v203
    buffer_store_dwordx2 v[50:51], v48, s[24:27], 0 offen
    v_cmp_eq_u32 vcc, 6, v49
    s_and_saveexec_b64 s[36:37], vcc
    v_lshrrev_b32 v52, 22, v48
    v_lshrrev_b32 v52, 17, v48
    v_cmp_le_u32 vcc, 32, v52
    v_mov_b32 v52, 0
    v_mov_b32 v53, 0x3f80
    v_cndmask_b32 v52, v52, v53, vcc
    v_mov_b32 v53, 0
    buffer_store_dwordx2 v[52:53], v48, s[24:27], 0 offen offset:8
    s_mov_b64 exec, s[36:37]
    s_nop 1
    v_add_u32 v47, 4, v46
    v_mul_u32_u24 v48, s38, v47
    v_lshrrev_b32 v48, 16, v48
    v_mul_u32_u24 v49, 7, v48
    v_sub_u32 v49, v47, v49
    v_lshl_add_u32 v48, v48, 11, v5
    v_lshlrev_b32 v48, 6, v48
    v_lshl_add_u32 v48, v49, 3, v48
    v_fma_f32 v204, v26, v132, v204
    v_mul_f32 v204, v204, v29
    v_fma_f32 v205, v26, v133, v205
    v_mul_f32 v205, v205, v29
    v_fma_f32 v206, v26, v134, v206
    v_mul_f32 v206, v206, v29
    v_fma_f32 v207, v26, v135, v207
    v_mul_f32 v207, v207, v29
    v_cvt_pk_bf16_f32 v50, v204, v205
    v_cvt_pk_bf16_f32 v51, v206, v207
    buffer_store_dwordx2 v[50:51], v48, s[24:27], 0 offen
    v_cmp_eq_u32 vcc, 6, v49
    s_and_saveexec_b64 s[36:37], vcc
    v_lshrrev_b32 v52, 22, v48
    v_lshrrev_b32 v52, 17, v48
    v_cmp_le_u32 vcc, 32, v52
    v_mov_b32 v52, 0
    v_mov_b32 v53, 0x3f80
    v_cndmask_b32 v52, v52, v53, vcc
    v_mov_b32 v53, 0
    buffer_store_dwordx2 v[52:53], v48, s[24:27], 0 offen offset:8
    s_mov_b64 exec, s[36:37]
    s_nop 1
    v_add_u32 v47, 8, v46
    v_mul_u32_u24 v48, s38, v47
    v_lshrrev_b32 v48, 16, v48
    v_mul_u32_u24 v49, 7, v48
    v_sub_u32 v49, v47, v49
    v_lshl_add_u32 v48, v48, 11, v5
    v_lshlrev_b32 v48, 6, v48
    v_lshl_add_u32 v48, v49, 3, v48
    v_fma_f32 v208, v26, v136, v208
    v_mul_f32 v208, v208, v29
    v_fma_f32 v209, v26, v137, v209
    v_mul_f32 v209, v209, v29
    v_fma_f32 v210, v26, v138, v210
    v_mul_f32 v210, v210, v29
    v_fma_f32 v211, v26, v139, v211
    v_mul_f32 v211, v211, v29
    v_cvt_pk_bf16_f32 v50, v208, v209
    v_cvt_pk_bf16_f32 v51, v210, v211
    buffer_store_dwordx2 v[50:51], v48, s[24:27], 0 offen
    v_cmp_eq_u32 vcc, 6, v49
    s_and_saveexec_b64 s[36:37], vcc
    v_lshrrev_b32 v52, 22, v48
    v_lshrrev_b32 v52, 17, v48
    v_cmp_le_u32 vcc, 32, v52
    v_mov_b32 v52, 0
    v_mov_b32 v53, 0x3f80
    v_cndmask_b32 v52, v52, v53, vcc
    v_mov_b32 v53, 0
    buffer_store_dwordx2 v[52:53], v48, s[24:27], 0 offen offset:8
    s_mov_b64 exec, s[36:37]
    s_nop 1
    v_add_u32 v47, 12, v46
    v_mul_u32_u24 v48, s38, v47
    v_lshrrev_b32 v48, 16, v48
    v_mul_u32_u24 v49, 7, v48
    v_sub_u32 v49, v47, v49
    v_lshl_add_u32 v48, v48, 11, v5
    v_lshlrev_b32 v48, 6, v48
    v_lshl_add_u32 v48, v49, 3, v48
    v_fma_f32 v212, v26, v140, v212
    v_mul_f32 v212, v212, v29
    v_fma_f32 v213, v26, v141, v213
    v_mul_f32 v213, v213, v29
    v_fma_f32 v214, v26, v142, v214
    v_mul_f32 v214, v214, v29
    v_fma_f32 v215, v26, v143, v215
    v_mul_f32 v215, v215, v29
    v_cvt_pk_bf16_f32 v50, v212, v213
    v_cvt_pk_bf16_f32 v51, v214, v215
    buffer_store_dwordx2 v[50:51], v48, s[24:27], 0 offen
    v_cmp_eq_u32 vcc, 6, v49
    s_and_saveexec_b64 s[36:37], vcc
    v_lshrrev_b32 v52, 22, v48
    v_lshrrev_b32 v52, 17, v48
    v_cmp_le_u32 vcc, 32, v52
    v_mov_b32 v52, 0
    v_mov_b32 v53, 0x3f80
    v_cndmask_b32 v52, v52, v53, vcc
    v_mov_b32 v53, 0
    buffer_store_dwordx2 v[52:53], v48, s[24:27], 0 offen offset:8
    s_mov_b64 exec, s[36:37]
    s_nop 1
    v_add_u32 v47, 16, v46
    v_mul_u32_u24 v48, s38, v47
    v_lshrrev_b32 v48, 16, v48
    v_mul_u32_u24 v49, 7, v48
    v_sub_u32 v49, v47, v49
    v_lshl_add_u32 v48, v48, 11, v5
    v_lshlrev_b32 v48, 6, v48
    v_lshl_add_u32 v48, v49, 3, v48
    v_fma_f32 v216, v26, v144, v216
    v_mul_f32 v216, v216, v29
    v_fma_f32 v217, v26, v145, v217
    v_mul_f32 v217, v217, v29
    v_fma_f32 v218, v26, v146, v218
    v_mul_f32 v218, v218, v29
    v_fma_f32 v219, v26, v147, v219
    v_mul_f32 v219, v219, v29
    v_cvt_pk_bf16_f32 v50, v216, v217
    v_cvt_pk_bf16_f32 v51, v218, v219
    buffer_store_dwordx2 v[50:51], v48, s[24:27], 0 offen
    v_cmp_eq_u32 vcc, 6, v49
    s_and_saveexec_b64 s[36:37], vcc
    v_lshrrev_b32 v52, 22, v48
    v_lshrrev_b32 v52, 17, v48
    v_cmp_le_u32 vcc, 32, v52
    v_mov_b32 v52, 0
    v_mov_b32 v53, 0x3f80
    v_cndmask_b32 v52, v52, v53, vcc
    v_mov_b32 v53, 0
    buffer_store_dwordx2 v[52:53], v48, s[24:27], 0 offen offset:8
    s_mov_b64 exec, s[36:37]
    s_nop 1
    v_add_u32 v47, 20, v46
    v_mul_u32_u24 v48, s38, v47
    v_lshrrev_b32 v48, 16, v48
    v_mul_u32_u24 v49, 7, v48
    v_sub_u32 v49, v47, v49
    v_lshl_add_u32 v48, v48, 11, v5
    v_lshlrev_b32 v48, 6, v48
    v_lshl_add_u32 v48, v49, 3, v48
    v_fma_f32 v220, v26, v148, v220
    v_mul_f32 v220, v220, v29
    v_fma_f32 v221, v26, v149, v221
    v_mul_f32 v221, v221, v29
    v_fma_f32 v222, v26, v150, v222
    v_mul_f32 v222, v222, v29
    v_fma_f32 v223, v26, v151, v223
    v_mul_f32 v223, v223, v29
    v_cvt_pk_bf16_f32 v50, v220, v221
    v_cvt_pk_bf16_f32 v51, v222, v223
    buffer_store_dwordx2 v[50:51], v48, s[24:27], 0 offen
    v_cmp_eq_u32 vcc, 6, v49
    s_and_saveexec_b64 s[36:37], vcc
    v_lshrrev_b32 v52, 22, v48
    v_lshrrev_b32 v52, 17, v48
    v_cmp_le_u32 vcc, 32, v52
    v_mov_b32 v52, 0
    v_mov_b32 v53, 0x3f80
    v_cndmask_b32 v52, v52, v53, vcc
    v_mov_b32 v53, 0
    buffer_store_dwordx2 v[52:53], v48, s[24:27], 0 offen offset:8
    s_mov_b64 exec, s[36:37]
    s_nop 1
    s_endpgm
K1_prefetch:
    s_load_dwordx4 s[4:7], s[0:1], 40
    s_load_dwordx2 s[8:9], s[0:1], 56
    s_sub_u32 s12, s2, 224
    s_mul_i32 s12, s12, 50176
    v_lshlrev_b32 v1, 4, v0
    v_add_u32 v1, s12, v1
    s_waitcnt lgkmcnt(0)
    s_mov_b32 s16, s4
    s_and_b32 s17, s5, 0xffff
    s_mov_b32 s18, 1605632
    s_mov_b32 s19, 0x00020000
    s_mov_b32 s20, s6
    s_and_b32 s21, s7, 0xffff
    s_mov_b32 s22, 1605632
    s_mov_b32 s23, 0x00020000
    s_mov_b32 s24, s8
    s_and_b32 s25, s9, 0xffff
    s_mov_b32 s26, 1605632
    s_mov_b32 s27, 0x00020000
    s_mov_b32 s13, 0
    buffer_load_dwordx4 v[16:19], v1, s[16:19], s13 offen
    s_mov_b32 s13, 8192
    buffer_load_dwordx4 v[20:23], v1, s[16:19], s13 offen
    s_mov_b32 s13, 16384
    buffer_load_dwordx4 v[24:27], v1, s[16:19], s13 offen
    s_mov_b32 s13, 24576
    buffer_load_dwordx4 v[28:31], v1, s[16:19], s13 offen
    s_mov_b32 s13, 32768
    buffer_load_dwordx4 v[32:35], v1, s[16:19], s13 offen
    s_mov_b32 s13, 40960
    buffer_load_dwordx4 v[36:39], v1, s[16:19], s13 offen
    v_cmp_gt_u32 vcc, 64, v0
    s_and_saveexec_b64 s[36:37], vcc
    s_cbranch_execz K1_pf0
    s_mov_b32 s13, 49152
    buffer_load_dwordx4 v[40:43], v1, s[16:19], s13 offen
K1_pf0:
    s_mov_b64 exec, s[36:37]
    s_mov_b32 s13, 0
    buffer_load_dwordx4 v[44:47], v1, s[20:23], s13 offen
    s_mov_b32 s13, 8192
    buffer_load_dwordx4 v[48:51], v1, s[20:23], s13 offen
    s_mov_b32 s13, 16384
    buffer_load_dwordx4 v[52:55], v1, s[20:23], s13 offen
    s_mov_b32 s13, 24576
    buffer_load_dwordx4 v[56:59], v1, s[20:23], s13 offen
    s_mov_b32 s13, 32768
    buffer_load_dwordx4 v[60:63], v1, s[20:23], s13 offen
    s_mov_b32 s13, 40960
    buffer_load_dwordx4 v[64:67], v1, s[20:23], s13 offen
    v_cmp_gt_u32 vcc, 64, v0
    s_and_saveexec_b64 s[36:37], vcc
    s_cbranch_execz K1_pf1
    s_mov_b32 s13, 49152
    buffer_load_dwordx4 v[68:71], v1, s[20:23], s13 offen
K1_pf1:
    s_mov_b64 exec, s[36:37]
    s_mov_b32 s13, 0
    buffer_load_dwordx4 v[72:75], v1, s[24:27], s13 offen
    s_mov_b32 s13, 8192
    buffer_load_dwordx4 v[76:79], v1, s[24:27], s13 offen
    s_mov_b32 s13, 16384
    buffer_load_dwordx4 v[80:83], v1, s[24:27], s13 offen
    s_mov_b32 s13, 24576
    buffer_load_dwordx4 v[84:87], v1, s[24:27], s13 offen
    s_mov_b32 s13, 32768
    buffer_load_dwordx4 v[88:91], v1, s[24:27], s13 offen
    s_mov_b32 s13, 40960
    buffer_load_dwordx4 v[92:95], v1, s[24:27], s13 offen
    v_cmp_gt_u32 vcc, 64, v0
    s_and_saveexec_b64 s[36:37], vcc
    s_cbranch_execz K1_pf2
    s_mov_b32 s13, 49152
    buffer_load_dwordx4 v[96:99], v1, s[24:27], s13 offen
K1_pf2:
    s_mov_b64 exec, s[36:37]
    s_waitcnt vmcnt(0)
K1_done:
    s_endpgm
.globl k2_kernel
.p2align 8
.type k2_kernel,@function
k2_kernel:
    s_cmp_ge_u32 s2, 312
    s_cbranch_scc1 K2_done
    s_load_dwordx2 s[4:5], s[0:1], 0
    s_load_dwordx4 s[8:11], s[0:1], 40
    s_load_dwordx2 s[12:13], s[0:1], 56
    s_load_dwordx2 s[14:15], s[0:1], 80
    v_and_b32 v1, 63, v0
    v_lshrrev_b32 v2, 6, v0
    v_and_b32 v3, 15, v0
    v_bfe_u32 v4, v0, 4, 2
    v_readfirstlane_b32 s34, v2
    s_waitcnt lgkmcnt(0)
    s_mov_b32 s24, s14
    s_and_b32 s25, s15, 0xffff
    s_mov_b32 s26, 8388608
    s_mov_b32 s27, 0x00020000
    s_cmp_lt_u32 s2, 56
    s_cbranch_scc1 K2_moe
    s_sub_u32 s16, s2, 56
    s_and_b32 s17, s16, 7
    s_lshl_b32 s17, s17, 1
    s_bfe_u32 s18, s16, 0x10003
    s_add_u32 s17, s17, s18
    s_lshr_b32 s18, s16, 4
    s_lshl_b32 s19, s18, 7
    s_sub_u32 s20, s19, 256
    s_add_u32 s21, s17, 16
    s_lshl_b32 s21, s21, 17
    v_lshrrev_b32 v5, 2, v1
    v_and_b32 v6, 3, v1
    v_lshrrev_b32 v7, 2, v5
    v_and_b32 v8, 2, v7
    v_xor_b32 v8, v8, v6
    v_and_b32 v9, 1, v7
    v_lshlrev_b32 v9, 1, v9
    v_xor_b32 v9, v9, v6
    v_lshlrev_b32 v8, 4, v8
    v_lshlrev_b32 v9, 4, v9
    s_lshl_b32 s35, s34, 10
    s_lshl_b32 s36, s34, 4
    v_add_u32 v10, 0, v5
    v_add_u32 v10, s36, v10
    v_add_u32 v10, s20, v10
    v_max_i32 v10, 0, v10
    v_min_i32 v10, 2047, v10
    v_lshl_add_u32 v10, v10, 6, v8
    s_add_u32 s37, s21, 0
    s_add_u32 s38, s35, 0
    s_mov_b32 m0, s38
    s_nop 0
    buffer_load_dwordx4 v10, s[24:27], s37 offen lds
    v_add_u32 v10, 128, v5
    v_add_u32 v10, s36, v10
    v_add_u32 v10, s20, v10
    v_max_i32 v10, 0, v10
    v_min_i32 v10, 2047, v10
    v_lshl_add_u32 v10, v10, 6, v8
    s_add_u32 s37, s21, 0
    s_add_u32 s38, s35, 8192
    s_mov_b32 m0, s38
    s_nop 0
    buffer_load_dwordx4 v10, s[24:27], s37 offen lds
    v_add_u32 v10, 256, v5
    v_add_u32 v10, s36, v10
    v_add_u32 v10, s20, v10
    v_max_i32 v10, 0, v10
    v_min_i32 v10, 2047, v10
    v_lshl_add_u32 v10, v10, 6, v8
    s_add_u32 s37, s21, 0
    s_add_u32 s38, s35, 16384
    s_mov_b32 m0, s38
    s_nop 0
    buffer_load_dwordx4 v10, s[24:27], s37 offen lds
    s_cmp_lg_u32 s34, 0
    s_cbranch_scc1 K2_nk3
    v_add_u32 v10, 384, v5
    v_add_u32 v10, s36, v10
    v_add_u32 v10, s20, v10
    v_max_i32 v10, 0, v10
    v_min_i32 v10, 2047, v10
    v_lshl_add_u32 v10, v10, 6, v8
    s_add_u32 s37, s21, 0
    s_add_u32 s38, s35, 24576
    s_mov_b32 m0, s38
    s_nop 0
    buffer_load_dwordx4 v10, s[24:27], s37 offen lds
K2_nk3:
    v_lshl_add_u32 v12, v2, 4, v3
    v_add_u32 v12, s19, v12
    s_lshl_b32 s22, s17, 11
    v_add_u32 v13, s22, v12
    v_lshlrev_b32 v13, 6, v13
    v_lshl_add_u32 v13, v4, 4, v13
    buffer_load_dwordx4 v[16:19], v13, s[24:27], 0 offen
    v_add_u32 v10, 0, v5
    v_add_u32 v10, s36, v10
    v_add_u32 v10, s20, v10
    v_max_i32 v10, 0, v10
    v_min_i32 v10, 2047, v10
    v_lshl_add_u32 v10, v10, 6, v9
    s_add_u32 s37, s21, 2097152
    s_add_u32 s38, s35, 25600
    s_mov_b32 m0, s38
    s_nop 0
    buffer_load_dwordx4 v10, s[24:27], s37 offen lds
    v_add_u32 v10, 128, v5
    v_add_u32 v10, s36, v10
    v_add_u32 v10, s20, v10
    v_max_i32 v10, 0, v10
    v_min_i32 v10, 2047, v10
    v_lshl_add_u32 v10, v10, 6, v9
    s_add_u32 s37, s21, 2097152
    s_add_u32 s38, s35, 33792
    s_mov_b32 m0, s38
    s_nop 0
    buffer_load_dwordx4 v10, s[24:27], s37 offen lds
    v_add_u32 v10, 256, v5
    v_add_u32 v10, s36, v10
    v_add_u32 v10, s20, v10
    v_max_i32 v10, 0, v10
    v_min_i32 v10, 2047, v10
    v_lshl_add_u32 v10, v10, 6, v9
    s_add_u32 s37, s21, 2097152
    s_add_u32 s38, s35, 41984
    s_mov_b32 m0, s38
    s_nop 0
    buffer_load_dwordx4 v10, s[24:27], s37 offen lds
    s_cmp_lg_u32 s34, 0
    s_cbranch_scc1 K2_nv3
    v_add_u32 v10, 384, v5
    v_add_u32 v10, s36, v10
    v_add_u32 v10, s20, v10
    v_max_i32 v10, 0, v10
    v_min_i32 v10, 2047, v10
    v_lshl_add_u32 v10, v10, 6, v9
    s_add_u32 s37, s21, 2097152
    s_add_u32 s38, s35, 50176
    s_mov_b32 m0, s38
    s_nop 0
    buffer_load_dwordx4 v10, s[24:27], s37 offen lds
K2_nv3:
    v_lshrrev_b32 v7, 2, v3
    v_and_b32 v7, 2, v7
    v_xor_b32 v7, v7, v4
    v_lshlrev_b32 v7, 4, v7
    v_lshl_add_u32 v22, v2, 4, v3
    v_lshl_add_u32 v7, v22, 6, v7
    s_lshl_b32 s28, s18, 3
    s_add_u32 s28, s28, s34
    s_sub_i32 s28, 16, s28
    s_max_i32 s28, s28, 0
    v_mov_b32 v23, 0xf149f2ca
    s_cmp_lg_u32 s34, 0
    s_cbranch_scc1 K2_w3
    s_waitcnt vmcnt(4)
    s_branch K2_w3d
K2_w3:
    s_waitcnt vmcnt(3)
K2_w3d:
    s_barrier
    ds_read_b128 v[104:107], v7 offset:0
    ds_read_b128 v[108:111], v7 offset:1024
    ds_read_b128 v[112:115], v7 offset:2048
    ds_read_b128 v[116:119], v7 offset:3072
    s_waitcnt lgkmcnt(3)
    v_mfma_f32_16x16x32_bf16 v[32:35], v[104:107], v[16:19], 0
    ds_read_b128 v[104:107], v7 offset:4096
    s_waitcnt lgkmcnt(3)
    v_mfma_f32_16x16x32_bf16 v[36:39], v[108:111], v[16:19], 0
    ds_read_b128 v[108:111], v7 offset:5120
    s_waitcnt lgkmcnt(3)
    v_mfma_f32_16x16x32_bf16 v[40:43], v[112:115], v[16:19], 0
    ds_read_b128 v[112:115], v7 offset:6144
    s_waitcnt lgkmcnt(3)
    v_mfma_f32_16x16x32_bf16 v[44:47], v[116:119], v[16:19], 0
    ds_read_b128 v[116:119], v7 offset:7168
    s_waitcnt lgkmcnt(3)
    v_mfma_f32_16x16x32_bf16 v[48:51], v[104:107], v[16:19], 0
    ds_read_b128 v[104:107], v7 offset:8192
    s_waitcnt lgkmcnt(3)
    v_mfma_f32_16x16x32_bf16 v[52:55], v[108:111], v[16:19], 0
    ds_read_b128 v[108:111], v7 offset:9216
    s_waitcnt lgkmcnt(3)
    v_mfma_f32_16x16x32_bf16 v[56:59], v[112:115], v[16:19], 0
    ds_read_b128 v[112:115], v7 offset:10240
    s_waitcnt lgkmcnt(3)
    v_mfma_f32_16x16x32_bf16 v[60:63], v[116:119], v[16:19], 0
    ds_read_b128 v[116:119], v7 offset:11264
    s_waitcnt lgkmcnt(3)
    v_mfma_f32_16x16x32_bf16 v[64:67], v[104:107], v[16:19], 0
    ds_read_b128 v[104:107], v7 offset:12288
    s_waitcnt lgkmcnt(3)
    v_mfma_f32_16x16x32_bf16 v[68:71], v[108:111], v[16:19], 0
    ds_read_b128 v[108:111], v7 offset:13312
    s_waitcnt lgkmcnt(3)
    v_mfma_f32_16x16x32_bf16 v[72:75], v[112:115], v[16:19], 0
    ds_read_b128 v[112:115], v7 offset:14336
    s_waitcnt lgkmcnt(3)
    v_mfma_f32_16x16x32_bf16 v[76:79], v[116:119], v[16:19], 0
    ds_read_b128 v[116:119], v7 offset:15360
    s_waitcnt lgkmcnt(3)
    v_mfma_f32_16x16x32_bf16 v[80:83], v[104:107], v[16:19], 0
    ds_read_b128 v[104:107], v7 offset:16384
    s_waitcnt lgkmcnt(3)
    v_mfma_f32_16x16x32_bf16 v[84:87], v[108:111], v[16:19], 0
    ds_read_b128 v[108:111], v7 offset:17408
    s_waitcnt lgkmcnt(3)
    v_mfma_f32_16x16x32_bf16 v[88:91], v[112:115], v[16:19], 0
    s_waitcnt lgkmcnt(2)
    v_mfma_f32_16x16x32_bf16 v[92:95], v[116:119], v[16:19], 0
    s_waitcnt lgkmcnt(1)
    v_mfma_f32_16x16x32_bf16 v[96:99], v[104:107], v[16:19], 0
    s_waitcnt lgkmcnt(0)
    v_mfma_f32_16x16x32_bf16 v[100:103], v[108:111], v[16:19], 0
    s_nop 7
    v_mov_b32 v100, v23
    v_mov_b32 v101, v23
    v_mov_b32 v102, v23
    v_mov_b32 v103, v23
    s_cmp_eq_u32 s28, 0
    s_cbranch_scc1 K2_noneg
    s_cmp_le_u32 s28, 0
    s_cbranch_scc1 K2_noneg
    v_mov_b32 v32, v23
    v_mov_b32 v33, v23
    v_mov_b32 v34, v23
    v_mov_b32 v35, v23
    s_cmp_le_u32 s28, 1
    s_cbranch_scc1 K2_noneg
    v_mov_b32 v36, v23
    v_mov_b32 v37, v23
    v_mov_b32 v38, v23
    v_mov_b32 v39, v23
    s_cmp_le_u32 s28, 2
    s_cbranch_scc1 K2_noneg
    v_mov_b32 v40, v23
    v_mov_b32 v41, v23
    v_mov_b32 v42, v23
    v_mov_b32 v43, v23
    s_cmp_le_u32 s28, 3
    s_cbranch_scc1 K2_noneg
    v_mov_b32 v44, v23
    v_mov_b32 v45, v23
    v_mov_b32 v46, v23
    v_mov_b32 v47, v23
    s_cmp_le_u32 s28, 4
    s_cbranch_scc1 K2_noneg
    v_mov_b32 v48, v23
    v_mov_b32 v49, v23
    v_mov_b32 v50, v23
    v_mov_b32 v51, v23
    s_cmp_le_u32 s28, 5
    s_cbranch_scc1 K2_noneg
    v_mov_b32 v52, v23
    v_mov_b32 v53, v23
    v_mov_b32 v54, v23
    v_mov_b32 v55, v23
    s_cmp_le_u32 s28, 6
    s_cbranch_scc1 K2_noneg
    v_mov_b32 v56, v23
    v_mov_b32 v57, v23
    v_mov_b32 v58, v23
    v_mov_b32 v59, v23
    s_cmp_le_u32 s28, 7
    s_cbranch_scc1 K2_noneg
    v_mov_b32 v60, v23
    v_mov_b32 v61, v23
    v_mov_b32 v62, v23
    v_mov_b32 v63, v23
    s_cmp_le_u32 s28, 8
    s_cbranch_scc1 K2_noneg
    v_mov_b32 v64, v23
    v_mov_b32 v65, v23
    v_mov_b32 v66, v23
    v_mov_b32 v67, v23
    s_cmp_le_u32 s28, 9
    s_cbranch_scc1 K2_noneg
    v_mov_b32 v68, v23
    v_mov_b32 v69, v23
    v_mov_b32 v70, v23
    v_mov_b32 v71, v23
    s_cmp_le_u32 s28, 10
    s_cbranch_scc1 K2_noneg
    v_mov_b32 v72, v23
    v_mov_b32 v73, v23
    v_mov_b32 v74, v23
    v_mov_b32 v75, v23
    s_cmp_le_u32 s28, 11
    s_cbranch_scc1 K2_noneg
    v_mov_b32 v76, v23
    v_mov_b32 v77, v23
    v_mov_b32 v78, v23
    v_mov_b32 v79, v23
    s_cmp_le_u32 s28, 12
    s_cbranch_scc1 K2_noneg
    v_mov_b32 v80, v23
    v_mov_b32 v81, v23
    v_mov_b32 v82, v23
    v_mov_b32 v83, v23
    s_cmp_le_u32 s28, 13
    s_cbranch_scc1 K2_noneg
    v_mov_b32 v84, v23
    v_mov_b32 v85, v23
    v_mov_b32 v86, v23
    v_mov_b32 v87, v23
    s_cmp_le_u32 s28, 14
    s_cbranch_scc1 K2_noneg
    v_mov_b32 v88, v23
    v_mov_b32 v89, v23
    v_mov_b32 v90, v23
    v_mov_b32 v91, v23
    s_cmp_le_u32 s28, 15
    s_cbranch_scc1 K2_noneg
    v_mov_b32 v92, v23
    v_mov_b32 v93, v23
    v_mov_b32 v94, v23
    v_mov_b32 v95, v23
K2_noneg:
    v_lshlrev_b32 v24, 2, v4
    v_sub_u32 v24, v3, v24
    v_cmp_gt_i32 vcc, 0, v24
    s_nop 1
    v_cndmask_b32 v32, v23, v32, vcc
    v_cndmask_b32 v96, v96, v23, vcc
    v_cmp_gt_i32 vcc, 1, v24
    s_nop 1
    v_cndmask_b32 v33, v23, v33, vcc
    v_cndmask_b32 v97, v97, v23, vcc
    v_cmp_gt_i32 vcc, 2, v24
    s_nop 1
    v_cndmask_b32 v34, v23, v34, vcc
    v_cndmask_b32 v98, v98, v23, vcc
    v_cmp_gt_i32 vcc, 3, v24
    s_nop 1
    v_cndmask_b32 v35, v23, v35, vcc
    v_cndmask_b32 v99, v99, v23, vcc
    v_max_f32 v25, v32, v33
    v_max3_f32 v25, v25, v34, v35
    v_max3_f32 v25, v25, v36, v37
    v_max3_f32 v25, v25, v38, v39
    v_max3_f32 v25, v25, v40, v41
    v_max3_f32 v25, v25, v42, v43
    v_max3_f32 v25, v25, v44, v45
    v_max3_f32 v25, v25, v46, v47
    v_max3_f32 v25, v25, v48, v49
    v_max3_f32 v25, v25, v50, v51
    v_max3_f32 v25, v25, v52, v53
    v_max3_f32 v25, v25, v54, v55
    v_max3_f32 v25, v25, v56, v57
    v_max3_f32 v25, v25, v58, v59
    v_max3_f32 v25, v25, v60, v61
    v_max3_f32 v25, v25, v62, v63
    v_max3_f32 v25, v25, v64, v65
    v_max3_f32 v25, v25, v66, v67
    v_max3_f32 v25, v25, v68, v69
    v_max3_f32 v25, v25, v70, v71
    v_max3_f32 v25, v25, v72, v73
    v_max3_f32 v25, v25, v74, v75
    v_max3_f32 v25, v25, v76, v77
    v_max3_f32 v25, v25, v78, v79
    v_max3_f32 v25, v25, v80, v81
    v_max3_f32 v25, v25, v82, v83
    v_max3_f32 v25, v25, v84, v85
    v_max3_f32 v25, v25, v86, v87
    v_max3_f32 v25, v25, v88, v89
    v_max3_f32 v25, v25, v90, v91
    v_max3_f32 v25, v25, v92, v93
    v_max3_f32 v25, v25, v94, v95
    v_max3_f32 v25, v25, v96, v97
    v_max3_f32 v25, v25, v98, v99
    ds_swizzle_b32 v26, v25 offset:0x401f
    s_waitcnt lgkmcnt(0)
    v_max_f32 v25, v25, v26
    v_mov_b32 v26, v25
    s_nop 1
    v_permlane32_swap_b32 v25, v26
    v_max_f32 v25, v25, v26
    s_mov_b32 s29, 0x3e8b97f6
    v_mul_f32 v25, s29, v25
    v_sub_f32 v25, 0, v25
    v_fma_f32 v32, v32, s29, v25
    v_exp_f32 v32, v32
    v_fma_f32 v33, v33, s29, v25
    v_exp_f32 v33, v33
    v_fma_f32 v34, v34, s29, v25
    v_exp_f32 v34, v34
    v_fma_f32 v35, v35, s29, v25
    v_exp_f32 v35, v35
    v_fma_f32 v36, v36, s29, v25
    v_exp_f32 v36, v36
    v_fma_f32 v37, v37, s29, v25
    v_exp_f32 v37, v37
    v_fma_f32 v38, v38, s29, v25
    v_exp_f32 v38, v38
    v_fma_f32 v39, v39, s29, v25
    v_exp_f32 v39, v39
    v_fma_f32 v40, v40, s29, v25
    v_exp_f32 v40, v40
    v_fma_f32 v41, v41, s29, v25
    v_exp_f32 v41, v41
    v_fma_f32 v42, v42, s29, v25
    v_exp_f32 v42, v42
    v_fma_f32 v43, v43, s29, v25
    v_exp_f32 v43, v43
    v_fma_f32 v44, v44, s29, v25
    v_exp_f32 v44, v44
    v_fma_f32 v45, v45, s29, v25
    v_exp_f32 v45, v45
    v_fma_f32 v46, v46, s29, v25
    v_exp_f32 v46, v46
    v_fma_f32 v47, v47, s29, v25
    v_exp_f32 v47, v47
    v_fma_f32 v48, v48, s29, v25
    v_exp_f32 v48, v48
    v_fma_f32 v49, v49, s29, v25
    v_exp_f32 v49, v49
    v_fma_f32 v50, v50, s29, v25
    v_exp_f32 v50, v50
    v_fma_f32 v51, v51, s29, v25
    v_exp_f32 v51, v51
    v_fma_f32 v52, v52, s29, v25
    v_exp_f32 v52, v52
    v_fma_f32 v53, v53, s29, v25
    v_exp_f32 v53, v53
    v_fma_f32 v54, v54, s29, v25
    v_exp_f32 v54, v54
    v_fma_f32 v55, v55, s29, v25
    v_exp_f32 v55, v55
    v_fma_f32 v56, v56, s29, v25
    v_exp_f32 v56, v56
    v_fma_f32 v57, v57, s29, v25
    v_exp_f32 v57, v57
    v_fma_f32 v58, v58, s29, v25
    v_exp_f32 v58, v58
    v_fma_f32 v59, v59, s29, v25
    v_exp_f32 v59, v59
    v_fma_f32 v60, v60, s29, v25
    v_exp_f32 v60, v60
    v_fma_f32 v61, v61, s29, v25
    v_exp_f32 v61, v61
    v_fma_f32 v62, v62, s29, v25
    v_exp_f32 v62, v62
    v_fma_f32 v63, v63, s29, v25
    v_exp_f32 v63, v63
    v_fma_f32 v64, v64, s29, v25
    v_exp_f32 v64, v64
    v_fma_f32 v65, v65, s29, v25
    v_exp_f32 v65, v65
    v_fma_f32 v66, v66, s29, v25
    v_exp_f32 v66, v66
    v_fma_f32 v67, v67, s29, v25
    v_exp_f32 v67, v67
    v_fma_f32 v68, v68, s29, v25
    v_exp_f32 v68, v68
    v_fma_f32 v69, v69, s29, v25
    v_exp_f32 v69, v69
    v_fma_f32 v70, v70, s29, v25
    v_exp_f32 v70, v70
    v_fma_f32 v71, v71, s29, v25
    v_exp_f32 v71, v71
    v_fma_f32 v72, v72, s29, v25
    v_exp_f32 v72, v72
    v_fma_f32 v73, v73, s29, v25
    v_exp_f32 v73, v73
    v_fma_f32 v74, v74, s29, v25
    v_exp_f32 v74, v74
    v_fma_f32 v75, v75, s29, v25
    v_exp_f32 v75, v75
    v_fma_f32 v76, v76, s29, v25
    v_exp_f32 v76, v76
    v_fma_f32 v77, v77, s29, v25
    v_exp_f32 v77, v77
    v_fma_f32 v78, v78, s29, v25
    v_exp_f32 v78, v78
    v_fma_f32 v79, v79, s29, v25
    v_exp_f32 v79, v79
    v_fma_f32 v80, v80, s29, v25
    v_exp_f32 v80, v80
    v_fma_f32 v81, v81, s29, v25
    v_exp_f32 v81, v81
    v_fma_f32 v82, v82, s29, v25
    v_exp_f32 v82, v82
    v_fma_f32 v83, v83, s29, v25
    v_exp_f32 v83, v83
    v_fma_f32 v84, v84, s29, v25
    v_exp_f32 v84, v84
    v_fma_f32 v85, v85, s29, v25
    v_exp_f32 v85, v85
    v_fma_f32 v86, v86, s29, v25
    v_exp_f32 v86, v86
    v_fma_f32 v87, v87, s29, v25
    v_exp_f32 v87, v87
    v_fma_f32 v88, v88, s29, v25
    v_exp_f32 v88, v88
    v_fma_f32 v89, v89, s29, v25
    v_exp_f32 v89, v89
    v_fma_f32 v90, v90, s29, v25
    v_exp_f32 v90, v90
    v_fma_f32 v91, v91, s29, v25
    v_exp_f32 v91, v91
    v_fma_f32 v92, v92, s29, v25
    v_exp_f32 v92, v92
    v_fma_f32 v93, v93, s29, v25
    v_exp_f32 v93, v93
    v_fma_f32 v94, v94, s29, v25
    v_exp_f32 v94, v94
    v_fma_f32 v95, v95, s29, v25
    v_exp_f32 v95, v95
    v_fma_f32 v96, v96, s29, v25
    v_exp_f32 v96, v96
    v_fma_f32 v97, v97, s29, v25
    v_exp_f32 v97, v97
    v_fma_f32 v98, v98, s29, v25
    v_exp_f32 v98, v98
    v_fma_f32 v99, v99, s29, v25
    v_exp_f32 v99, v99
    v_mov_b32 v100, 0
    v_mov_b32 v101, 0
    v_mov_b32 v102, 0
    v_mov_b32 v103, 0
    v_cvt_pk_bf16_f32 v32, v32, v33
    v_cvt_pk_bf16_f32 v33, v34, v35
    v_cvt_pk_bf16_f32 v34, v36, v37
    v_cvt_pk_bf16_f32 v35, v38, v39
    v_cvt_pk_bf16_f32 v40, v40, v41
    v_cvt_pk_bf16_f32 v41, v42, v43
    v_cvt_pk_bf16_f32 v42, v44, v45
    v_cvt_pk_bf16_f32 v43, v46, v47
    v_cvt_pk_bf16_f32 v48, v48, v49
    v_cvt_pk_bf16_f32 v49, v50, v51
    v_cvt_pk_bf16_f32 v50, v52, v53
    v_cvt_pk_bf16_f32 v51, v54, v55
    v_cvt_pk_bf16_f32 v56, v56, v57
    v_cvt_pk_bf16_f32 v57, v58, v59
    v_cvt_pk_bf16_f32 v58, v60, v61
    v_cvt_pk_bf16_f32 v59, v62, v63
    v_cvt_pk_bf16_f32 v64, v64, v65
    v_cvt_pk_bf16_f32 v65, v66, v67
    v_cvt_pk_bf16_f32 v66, v68, v69
    v_cvt_pk_bf16_f32 v67, v70, v71
    v_cvt_pk_bf16_f32 v72, v72, v73
    v_cvt_pk_bf16_f32 v73, v74, v75
    v_cvt_pk_bf16_f32 v74, v76, v77
    v_cvt_pk_bf16_f32 v75, v78, v79
    v_cvt_pk_bf16_f32 v80, v80, v81
    v_cvt_pk_bf16_f32 v81, v82, v83
    v_cvt_pk_bf16_f32 v82, v84, v85
    v_cvt_pk_bf16_f32 v83, v86, v87
    v_cvt_pk_bf16_f32 v88, v88, v89
    v_cvt_pk_bf16_f32 v89, v90, v91
    v_cvt_pk_bf16_f32 v90, v92, v93
    v_cvt_pk_bf16_f32 v91, v94, v95
    v_cvt_pk_bf16_f32 v96, v96, v97
    v_cvt_pk_bf16_f32 v97, v98, v99
    v_cvt_pk_bf16_f32 v98, v100, v101
    v_cvt_pk_bf16_f32 v99, v102, v103
    v_lshrrev_b32 v24, 2, v3
    v_lshl_add_u32 v24, v4, 2, v24
    v_lshl_add_u32 v24, v2, 4, v24
    v_lshlrev_b32 v24, 6, v24
    v_and_b32 v26, 3, v3
    v_lshl_add_u32 v24, v26, 3, v24
    v_add_u32 v24, 25600, v24
    v_and_b32 v26, 1, v4
    v_lshl_add_u32 v27, v26, 5, v24
    v_xor_b32 v26, 1, v26
    v_lshl_add_u32 v28, v26, 5, v24
    v_mov_b32 v20, 0
    v_mov_b32 v21, 0
    v_mov_b32 v22, 0
    v_mov_b32 v23, 0
    v_mov_b32 v8, 0
    v_mov_b32 v9, 0
    v_mov_b32 v10, 0
    v_mov_b32 v11, 0
    s_waitcnt vmcnt(0)
    s_barrier
    ds_read_b64_tr_b16 v[104:105], v27 offset:0
    ds_read_b64_tr_b16 v[106:107], v27 offset:1024
    ds_read_b64_tr_b16 v[108:109], v28 offset:0
    ds_read_b64_tr_b16 v[110:111], v28 offset:1024
    ds_read_b64_tr_b16 v[112:113], v27 offset:2048
    ds_read_b64_tr_b16 v[114:115], v27 offset:3072
    ds_read_b64_tr_b16 v[116:117], v28 offset:2048
    ds_read_b64_tr_b16 v[118:119], v28 offset:3072
    s_waitcnt lgkmcnt(4)
    v_mfma_f32_16x16x32_bf16 v[20:23], v[104:107], v[32:35], v[20:23]
    v_mfma_f32_16x16x32_bf16 v[8:11], v[108:111], v[32:35], v[8:11]
    ds_read_b64_tr_b16 v[104:105], v27 offset:4096
    ds_read_b64_tr_b16 v[106:107], v27 offset:5120
    ds_read_b64_tr_b16 v[108:109], v28 offset:4096
    ds_read_b64_tr_b16 v[110:111], v28 offset:5120
    s_waitcnt lgkmcnt(4)
    v_mfma_f32_16x16x32_bf16 v[20:23], v[112:115], v[40:43], v[20:23]
    v_mfma_f32_16x16x32_bf16 v[8:11], v[116:119], v[40:43], v[8:11]
    ds_read_b64_tr_b16 v[112:113], v27 offset:6144
    ds_read_b64_tr_b16 v[114:115], v27 offset:7168
    ds_read_b64_tr_b16 v[116:117], v28 offset:6144
    ds_read_b64_tr_b16 v[118:119], v28 offset:7168
    s_waitcnt lgkmcnt(4)
    v_mfma_f32_16x16x32_bf16 v[20:23], v[104:107], v[48:51], v[20:23]
    v_mfma_f32_16x16x32_bf16 v[8:11], v[108:111], v[48:51], v[8:11]
    ds_read_b64_tr_b16 v[104:105], v27 offset:8192
    ds_read_b64_tr_b16 v[106:107], v27 offset:9216
    ds_read_b64_tr_b16 v[108:109], v28 offset:8192
    ds_read_b64_tr_b16 v[110:111], v28 offset:9216
    s_waitcnt lgkmcnt(4)
    v_mfma_f32_16x16x32_bf16 v[20:23], v[112:115], v[56:59], v[20:23]
    v_mfma_f32_16x16x32_bf16 v[8:11], v[116:119], v[56:59], v[8:11]
    ds_read_b64_tr_b16 v[112:113], v27 offset:10240
    ds_read_b64_tr_b16 v[114:115], v27 offset:11264
    ds_read_b64_tr_b16 v[116:117], v28 offset:10240
    ds_read_b64_tr_b16 v[118:119], v28 offset:11264
    s_waitcnt lgkmcnt(4)
    v_mfma_f32_16x16x32_bf16 v[20:23], v[104:107], v[64:67], v[20:23]
    v_mfma_f32_16x16x32_bf16 v[8:11], v[108:111], v[64:67], v[8:11]
    ds_read_b64_tr_b16 v[104:105], v27 offset:12288
    ds_read_b64_tr_b16 v[106:107], v27 offset:13312
    ds_read_b64_tr_b16 v[108:109], v28 offset:12288
    ds_read_b64_tr_b16 v[110:111], v28 offset:13312
    s_waitcnt lgkmcnt(4)
    v_mfma_f32_16x16x32_bf16 v[20:23], v[112:115], v[72:75], v[20:23]
    v_mfma_f32_16x16x32_bf16 v[8:11], v[116:119], v[72:75], v[8:11]
    ds_read_b64_tr_b16 v[112:113], v27 offset:14336
    ds_read_b64_tr_b16 v[114:115], v27 offset:15360
    ds_read_b64_tr_b16 v[116:117], v28 offset:14336
    ds_read_b64_tr_b16 v[118:119], v28 offset:15360
    s_waitcnt lgkmcnt(4)
    v_mfma_f32_16x16x32_bf16 v[20:23], v[104:107], v[80:83], v[20:23]
    v_mfma_f32_16x16x32_bf16 v[8:11], v[108:111], v[80:83], v[8:11]
    ds_read_b64_tr_b16 v[104:105], v27 offset:16384
    ds_read_b64_tr_b16 v[106:107], v27 offset:17408
    ds_read_b64_tr_b16 v[108:109], v28 offset:16384
    ds_read_b64_tr_b16 v[110:111], v28 offset:17408
    s_waitcnt lgkmcnt(4)
    v_mfma_f32_16x16x32_bf16 v[20:23], v[112:115], v[88:91], v[20:23]
    v_mfma_f32_16x16x32_bf16 v[8:11], v[116:119], v[88:91], v[8:11]
    s_waitcnt lgkmcnt(0)
    v_mfma_f32_16x16x32_bf16 v[20:23], v[104:107], v[96:99], v[20:23]
    v_mfma_f32_16x16x32_bf16 v[8:11], v[108:111], v[96:99], v[8:11]
    s_nop 7
    v_add_u32 v24, 48, v3
    v_lshlrev_b32 v24, 2, v24
    ds_bpermute_b32 v25, v24, v8
    s_waitcnt lgkmcnt(0)
    v_rcp_f32 v25, v25
    v_mul_u32_u24 v13, 896, v12
    s_mul_i32 s30, s17, 56
    v_add_u32 v13, s30, v13
    v_lshl_add_u32 v13, v4, 3, v13
    v_add_u32 v13, 6291456, v13
    v_mul_f32 v20, v20, v25
    v_mul_f32 v8, v8, v25
    v_mul_f32 v21, v21, v25
    v_mul_f32 v9, v9, v25
    v_mul_f32 v22, v22, v25
    v_mul_f32 v10, v10, v25
    v_mul_f32 v23, v23, v25
    v_mul_f32 v11, v11, v25
    v_cvt_pk_bf16_f32 v26, v20, v21
    v_cvt_pk_bf16_f32 v27, v22, v23
    v_cvt_pk_bf16_f32 v28, v8, v9
    v_cvt_pk_bf16_f32 v29, v10, v11
    buffer_store_dwordx2 v[26:27], v13, s[24:27], 0 offen
    v_cmp_gt_u32 vcc, 3, v4
    s_and_saveexec_b64 s[36:37], vcc
    buffer_store_dwordx2 v[28:29], v13, s[24:27], 0 offen offset:32
    s_branch K2_done
K2_moe:
    s_mov_b32 s16, s4
    s_and_b32 s17, s5, 0xffff
    s_mov_b32 s18, 1835008
    s_mov_b32 s19, 0x00020000
    s_mov_b32 s20, s8
    s_and_b32 s21, s9, 0xffff
    s_mov_b32 s22, 1605632
    s_mov_b32 s23, 0x00020000
    s_mov_b32 s28, s10
    s_and_b32 s29, s11, 0xffff
    s_mov_b32 s30, 1605632
    s_mov_b32 s31, 0x00020000
    s_mov_b32 s56, s12
    s_and_b32 s57, s13, 0xffff
    s_mov_b32 s58, 1605632
    s_mov_b32 s59, 0x00020000
    v_lshlrev_b32 v5, 4, v1
    v_add_u32 v5, 8142848, v5
    v_add_u32 v6, 4096, v5
    buffer_load_dwordx4 v[64:67], v5, s[24:27], 0 offen offset:0
    buffer_load_dwordx4 v[68:71], v5, s[24:27], 0 offen offset:1024
    buffer_load_dwordx4 v[72:75], v5, s[24:27], 0 offen offset:2048
    buffer_load_dwordx4 v[76:79], v5, s[24:27], 0 offen offset:3072
    buffer_load_dwordx4 v[80:83], v6, s[24:27], 0 offen offset:0
    buffer_load_dwordx4 v[84:87], v6, s[24:27], 0 offen offset:1024
    buffer_load_dwordx4 v[88:91], v6, s[24:27], 0 offen offset:2048
    buffer_load_dwordx4 v[92:95], v6, s[24:27], 0 offen offset:3072
    v_lshrrev_b32 v7, 2, v1
    v_lshl_add_u32 v7, v2, 4, v7
    v_mul_u32_u24 v7, 3584, v7
    v_and_b32 v8, 3, v1
    v_lshl_add_u32 v7, v8, 4, v7
    s_lshl_b32 s36, s2, 6
    v_add_u32 v7, s36, v7
    s_lshl_b32 s54, s34, 10
    s_mov_b32 s37, 0
    s_add_u32 s38, s54, 0
    s_mov_b32 m0, s38
    s_nop 0
    buffer_load_dwordx4 v7, s[20:23], s37 offen lds
    s_mov_b32 s37, 458752
    s_add_u32 s38, s54, 8192
    s_mov_b32 m0, s38
    s_nop 0
    buffer_load_dwordx4 v7, s[20:23], s37 offen lds
    s_mov_b32 s37, 917504
    s_add_u32 s38, s54, 16384
    s_mov_b32 m0, s38
    s_nop 0
    buffer_load_dwordx4 v7, s[20:23], s37 offen lds
    s_cmp_ge_u32 s34, 4
    s_cbranch_scc1 K2_mskip0
    s_mov_b32 s37, 1376256
    s_add_u32 s38, s54, 24576
    s_mov_b32 m0, s38
    s_nop 0
    buffer_load_dwordx4 v7, s[20:23], s37 offen lds
K2_mskip0:
    s_mov_b32 s37, 0
    s_add_u32 s38, s54, 28672
    s_mov_b32 m0, s38
    s_nop 0
    buffer_load_dwordx4 v7, s[28:31], s37 offen lds
    s_mov_b32 s37, 458752
    s_add_u32 s38, s54, 36864
    s_mov_b32 m0, s38
    s_nop 0
    buffer_load_dwordx4 v7, s[28:31], s37 offen lds
    s_mov_b32 s37, 917504
    s_add_u32 s38, s54, 45056
    s_mov_b32 m0, s38
    s_nop 0
    buffer_load_dwordx4 v7, s[28:31], s37 offen lds
    s_cmp_ge_u32 s34, 4
    s_cbranch_scc1 K2_mskip1
    s_mov_b32 s37, 1376256
    s_add_u32 s38, s54, 53248
    s_mov_b32 m0, s38
    s_nop 0
    buffer_load_dwordx4 v7, s[28:31], s37 offen lds
K2_mskip1:
    s_lshl_b32 s39, s2, 5
    v_add_u32 v9, 0, v0
    v_mul_u32_u24 v10, 4682, v9
    v_lshrrev_b32 v10, 18, v10
    v_mul_u32_u24 v11, 56, v10
    v_sub_u32 v11, v9, v11
    v_mul_u32_u24 v112, 896, v10
    v_lshl_add_u32 v112, v11, 4, v112
    v_add_u32 v10, s39, v10
    v_mul_u32_u24 v10, 896, v10
    v_lshl_add_u32 v10, v11, 4, v10
    v_cmp_gt_u32 vcc, 1792, v9
    v_mov_b32 v11, 0x7ffffff0
    s_nop 0
    v_cndmask_b32 v10, v11, v10, vcc
    buffer_load_dwordx4 v[96:99], v10, s[56:59], 0 offen
    v_add_u32 v9, 512, v0
    v_mul_u32_u24 v10, 4682, v9
    v_lshrrev_b32 v10, 18, v10
    v_mul_u32_u24 v11, 56, v10
    v_sub_u32 v11, v9, v11
    v_mul_u32_u24 v113, 896, v10
    v_lshl_add_u32 v113, v11, 4, v113
    v_add_u32 v10, s39, v10
    v_mul_u32_u24 v10, 896, v10
    v_lshl_add_u32 v10, v11, 4, v10
    v_cmp_gt_u32 vcc, 1792, v9
    v_mov_b32 v11, 0x7ffffff0
    s_nop 0
    v_cndmask_b32 v10, v11, v10, vcc
    buffer_load_dwordx4 v[100:103], v10, s[56:59], 0 offen
    v_add_u32 v9, 1024, v0
    v_mul_u32_u24 v10, 4682, v9
    v_lshrrev_b32 v10, 18, v10
    v_mul_u32_u24 v11, 56, v10
    v_sub_u32 v11, v9, v11
    v_mul_u32_u24 v114, 896, v10
    v_lshl_add_u32 v114, v11, 4, v114
    v_add_u32 v10, s39, v10
    v_mul_u32_u24 v10, 896, v10
    v_lshl_add_u32 v10, v11, 4, v10
    v_cmp_gt_u32 vcc, 1792, v9
    v_mov_b32 v11, 0x7ffffff0
    s_nop 0
    v_cndmask_b32 v10, v11, v10, vcc
    buffer_load_dwordx4 v[104:107], v10, s[56:59], 0 offen
    v_add_u32 v9, 1536, v0
    v_mul_u32_u24 v10, 4682, v9
    v_lshrrev_b32 v10, 18, v10
    v_mul_u32_u24 v11, 56, v10
    v_sub_u32 v11, v9, v11
    v_mul_u32_u24 v115, 896, v10
    v_lshl_add_u32 v115, v11, 4, v115
    v_add_u32 v10, s39, v10
    v_mul_u32_u24 v10, 896, v10
    v_lshl_add_u32 v10, v11, 4, v10
    v_cmp_gt_u32 vcc, 1792, v9
    v_mov_b32 v11, 0x7ffffff0
    s_nop 0
    v_cndmask_b32 v10, v11, v10, vcc
    buffer_load_dwordx4 v[108:111], v10, s[56:59], 0 offen
    s_cmp_ge_u32 s34, 4
    s_cbranch_scc1 K2_mw1
    s_waitcnt vmcnt(12)
    s_branch K2_mw2
K2_mw1:
    s_waitcnt vmcnt(10)
K2_mw2:
    v_lshlrev_b32 v10, 2, v1
    v_add_u32 v11, 0, v10
    v_or_b32 v64, v64, v11
    v_add_u32 v11, 1, v10
    v_or_b32 v65, v65, v11
    v_add_u32 v11, 2, v10
    v_or_b32 v66, v66, v11
    v_add_u32 v11, 3, v10
    v_or_b32 v67, v67, v11
    v_add_u32 v11, 256, v10
    v_or_b32 v68, v68, v11
    v_add_u32 v11, 257, v10
    v_or_b32 v69, v69, v11
    v_add_u32 v11, 258, v10
    v_or_b32 v70, v70, v11
    v_add_u32 v11, 259, v10
    v_or_b32 v71, v71, v11
    v_add_u32 v11, 512, v10
    v_or_b32 v72, v72, v11
    v_add_u32 v11, 513, v10
    v_or_b32 v73, v73, v11
    v_add_u32 v11, 514, v10
    v_or_b32 v74, v74, v11
    v_add_u32 v11, 515, v10
    v_or_b32 v75, v75, v11
    v_add_u32 v11, 768, v10
    v_or_b32 v76, v76, v11
    v_add_u32 v11, 769, v10
    v_or_b32 v77, v77, v11
    v_add_u32 v11, 770, v10
    v_or_b32 v78, v78, v11
    v_add_u32 v11, 771, v10
    v_or_b32 v79, v79, v11
    v_add_u32 v11, 1024, v10
    v_or_b32 v80, v80, v11
    v_add_u32 v11, 1025, v10
    v_or_b32 v81, v81, v11
    v_add_u32 v11, 1026, v10
    v_or_b32 v82, v82, v11
    v_add_u32 v11, 1027, v10
    v_or_b32 v83, v83, v11
    v_add_u32 v11, 1280, v10
    v_or_b32 v84, v84, v11
    v_add_u32 v11, 1281, v10
    v_or_b32 v85, v85, v11
    v_add_u32 v11, 1282, v10
    v_or_b32 v86, v86, v11
    v_add_u32 v11, 1283, v10
    v_or_b32 v87, v87, v11
    v_add_u32 v11, 1536, v10
    v_or_b32 v88, v88, v11
    v_add_u32 v11, 1537, v10
    v_or_b32 v89, v89, v11
    v_add_u32 v11, 1538, v10
    v_or_b32 v90, v90, v11
    v_add_u32 v11, 1539, v10
    v_or_b32 v91, v91, v11
    v_add_u32 v11, 1792, v10
    v_or_b32 v92, v92, v11
    v_add_u32 v11, 1793, v10
    v_or_b32 v93, v93, v11
    v_add_u32 v11, 1794, v10
    v_or_b32 v94, v94, v11
    v_add_u32 v11, 1795, v10
    v_or_b32 v95, v95, v11
    v_max_f32 v13, v64, v65
    v_min_f32 v14, v64, v65
    v_med3_f32 v14, v13, v14, v66
    v_max_f32 v13, v13, v66
    v_med3_f32 v14, v13, v14, v67
    v_max_f32 v13, v13, v67
    v_med3_f32 v14, v13, v14, v68
    v_max_f32 v13, v13, v68
    v_med3_f32 v14, v13, v14, v69
    v_max_f32 v13, v13, v69
    v_med3_f32 v14, v13, v14, v70
    v_max_f32 v13, v13, v70
    v_med3_f32 v14, v13, v14, v71
    v_max_f32 v13, v13, v71
    v_med3_f32 v14, v13, v14, v72
    v_max_f32 v13, v13, v72
    v_med3_f32 v14, v13, v14, v73
    v_max_f32 v13, v13, v73
    v_med3_f32 v14, v13, v14, v74
    v_max_f32 v13, v13, v74
    v_med3_f32 v14, v13, v14, v75
    v_max_f32 v13, v13, v75
    v_med3_f32 v14, v13, v14, v76
    v_max_f32 v13, v13, v76
    v_med3_f32 v14, v13, v14, v77
    v_max_f32 v13, v13, v77
    v_med3_f32 v14, v13, v14, v78
    v_max_f32 v13, v13, v78
    v_med3_f32 v14, v13, v14, v79
    v_max_f32 v13, v13, v79
    v_med3_f32 v14, v13, v14, v80
    v_max_f32 v13, v13, v80
    v_med3_f32 v14, v13, v14, v81
    v_max_f32 v13, v13, v81
    v_med3_f32 v14, v13, v14, v82
    v_max_f32 v13, v13, v82
    v_med3_f32 v14, v13, v14, v83
    v_max_f32 v13, v13, v83
    v_med3_f32 v14, v13, v14, v84
    v_max_f32 v13, v13, v84
    v_med3_f32 v14, v13, v14, v85
    v_max_f32 v13, v13, v85
    v_med3_f32 v14, v13, v14, v86
    v_max_f32 v13, v13, v86
    v_med3_f32 v14, v13, v14, v87
    v_max_f32 v13, v13, v87
    v_med3_f32 v14, v13, v14, v88
    v_max_f32 v13, v13, v88
    v_med3_f32 v14, v13, v14, v89
    v_max_f32 v13, v13, v89
    v_med3_f32 v14, v13, v14, v90
    v_max_f32 v13, v13, v90
    v_med3_f32 v14, v13, v14, v91
    v_max_f32 v13, v13, v91
    v_med3_f32 v14, v13, v14, v92
    v_max_f32 v13, v13, v92
    v_med3_f32 v14, v13, v14, v93
    v_max_f32 v13, v13, v93
    v_med3_f32 v14, v13, v14, v94
    v_max_f32 v13, v13, v94
    v_med3_f32 v14, v13, v14, v95
    v_max_f32 v13, v13, v95
    ds_swizzle_b32 v15, v13 offset:0x041f
    ds_swizzle_b32 v16, v14 offset:0x041f
    s_waitcnt lgkmcnt(0)
    v_min_f32 v17, v13, v15
    v_max_f32 v13, v13, v15
    v_max_f32 v14, v14, v16
    v_max_f32 v14, v14, v17
    ds_swizzle_b32 v15, v13 offset:0x081f
    ds_swizzle_b32 v16, v14 offset:0x081f
    s_waitcnt lgkmcnt(0)
    v_min_f32 v17, v13, v15
    v_max_f32 v13, v13, v15
    v_max_f32 v14, v14, v16
    v_max_f32 v14, v14, v17
    ds_swizzle_b32 v15, v13 offset:0x101f
    ds_swizzle_b32 v16, v14 offset:0x101f
    s_waitcnt lgkmcnt(0)
    v_min_f32 v17, v13, v15
    v_max_f32 v13, v13, v15
    v_max_f32 v14, v14, v16
    v_max_f32 v14, v14, v17
    ds_swizzle_b32 v15, v13 offset:0x201f
    ds_swizzle_b32 v16, v14 offset:0x201f
    s_waitcnt lgkmcnt(0)
    v_min_f32 v17, v13, v15
    v_max_f32 v13, v13, v15
    v_max_f32 v14, v14, v16
    v_max_f32 v14, v14, v17
    ds_swizzle_b32 v15, v13 offset:0x401f
    ds_swizzle_b32 v16, v14 offset:0x401f
    s_waitcnt lgkmcnt(0)
    v_min_f32 v17, v13, v15
    v_max_f32 v13, v13, v15
    v_max_f32 v14, v14, v16
    v_max_f32 v14, v14, v17
    v_mov_b32 v15, v13
    v_mov_b32 v16, v14
    s_nop 1
    v_permlane32_swap_b32 v13, v15
    v_permlane32_swap_b32 v14, v16
    v_min_f32 v17, v13, v15
    v_max_f32 v13, v13, v15
    v_max_f32 v14, v14, v16
    v_max_f32 v14, v14, v17
    s_nop 0
    v_readfirstlane_b32 s41, v13
    v_readfirstlane_b32 s42, v14
    s_nop 3
    s_and_b32 s43, s41, 0xffff
    s_and_b32 s44, s42, 0xffff
    s_and_b32 s45, s41, 0xffff0000
    s_and_b32 s46, s42, 0xffff0000
    v_cmp_gt_u32 vcc, 224, v0
    s_and_saveexec_b64 s[48:49], vcc
    s_mul_i32 s50, s43, 896
    v_lshlrev_b32 v11, 2, v0
    buffer_load_dword v16, v11, s[16:19], s50 offen
    s_lshl_b32 s51, s43, 3
    s_add_u32 s51, s51, 8126464
    v_mov_b32 v12, s51
    buffer_load_dwordx2 v[18:19], v12, s[24:27], 0 offen
    s_mul_i32 s50, s44, 896
    v_lshlrev_b32 v11, 2, v0
    buffer_load_dword v17, v11, s[16:19], s50 offen
    s_lshl_b32 s51, s44, 3
    s_add_u32 s51, s51, 8126464
    v_mov_b32 v12, s51
    buffer_load_dwordx2 v[20:21], v12, s[24:27], 0 offen
    s_waitcnt vmcnt(0)
    v_rcp_f32 v22, v19
    v_lshlrev_b32 v23, 16, v16
    v_and_b32 v24, 0xffff0000, v16
    v_sub_f32 v23, v23, v18
    v_sub_f32 v24, v24, v18
    v_cvt_pk_bf16_f32 v25, v23, v24
    v_lshlrev_b32 v23, 16, v25
    v_and_b32 v24, 0xffff0000, v25
    v_mul_f32 v23, v23, v22
    v_mul_f32 v24, v24, v22
    v_cvt_pk_bf16_f32 v25, v23, v24
    v_lshlrev_b32 v28, 2, v0
    ds_write_b32 v28, v25 offset:57344
    v_rcp_f32 v22, v21
    v_lshlrev_b32 v23, 16, v17
    v_and_b32 v24, 0xffff0000, v17
    v_sub_f32 v23, v23, v20
    v_sub_f32 v24, v24, v20
    v_cvt_pk_bf16_f32 v25, v23, v24
    v_lshlrev_b32 v23, 16, v25
    v_and_b32 v24, 0xffff0000, v25
    v_mul_f32 v23, v23, v22
    v_mul_f32 v24, v24, v22
    v_cvt_pk_bf16_f32 v25, v23, v24
    v_lshlrev_b32 v28, 2, v0
    ds_write_b32 v28, v25 offset:58240
    s_mov_b64 exec, s[48:49]
    s_waitcnt vmcnt(0) lgkmcnt(0)
    s_barrier
    s_cmp_ge_u32 s34, 4
    s_cbranch_scc1 K2_mnogu
    v_and_b32 v11, 1, v3
    v_mul_u32_u24 v11, 896, v11
    v_lshl_add_u32 v11, v4, 4, v11
    v_lshrrev_b32 v12, 2, v3
    v_lshl_add_u32 v12, v4, 3, v12
    v_lshlrev_b32 v12, 6, v12
    v_and_b32 v13, 3, v3
    v_lshl_add_u32 v12, v13, 3, v12
    s_lshr_b32 s50, s34, 1
    s_mul_i32 s50, s50, 28672
    s_and_b32 s51, s34, 1
    s_lshl_b32 s51, s51, 5
    s_add_u32 s50, s50, s51
    v_add_u32 v12, s50, v12
    v_mov_b32 v20, 0
    v_mov_b32 v21, 0
    v_mov_b32 v22, 0
    v_mov_b32 v23, 0
    ds_read_b128 v[32:35], v11 offset:57344
    ds_read_b64_tr_b16 v[36:37], v12 offset:0
    ds_read_b64_tr_b16 v[38:39], v12 offset:256
    ds_read_b128 v[40:43], v11 offset:57408
    ds_read_b64_tr_b16 v[44:45], v12 offset:2048
    ds_read_b64_tr_b16 v[46:47], v12 offset:2304
    ds_read_b128 v[48:51], v11 offset:57472
    ds_read_b64_tr_b16 v[52:53], v12 offset:4096
    ds_read_b64_tr_b16 v[54:55], v12 offset:4352
    ds_read_b128 v[56:59], v11 offset:57536
    ds_read_b64_tr_b16 v[60:61], v12 offset:6144
    ds_read_b64_tr_b16 v[62:63], v12 offset:6400
    ds_read_b128 v[64:67], v11 offset:57600
    ds_read_b64_tr_b16 v[68:69], v12 offset:8192
    ds_read_b64_tr_b16 v[70:71], v12 offset:8448
    ds_read_b128 v[72:75], v11 offset:57664
    ds_read_b64_tr_b16 v[76:77], v12 offset:10240
    ds_read_b64_tr_b16 v[78:79], v12 offset:10496
    ds_read_b128 v[80:83], v11 offset:57728
    ds_read_b64_tr_b16 v[84:85], v12 offset:12288
    ds_read_b64_tr_b16 v[86:87], v12 offset:12544
    s_waitcnt lgkmcnt(15)
    v_mfma_f32_16x16x32_bf16 v[20:23], v[32:35], v[36:39], v[20:23]
    s_waitcnt lgkmcnt(15)
    v_mfma_f32_16x16x32_bf16 v[20:23], v[40:43], v[44:47], v[20:23]
    s_waitcnt lgkmcnt(12)
    v_mfma_f32_16x16x32_bf16 v[20:23], v[48:51], v[52:55], v[20:23]
    s_waitcnt lgkmcnt(9)
    v_mfma_f32_16x16x32_bf16 v[20:23], v[56:59], v[60:63], v[20:23]
    s_waitcnt lgkmcnt(6)
    v_mfma_f32_16x16x32_bf16 v[20:23], v[64:67], v[68:71], v[20:23]
    s_waitcnt lgkmcnt(3)
    v_mfma_f32_16x16x32_bf16 v[20:23], v[72:75], v[76:79], v[20:23]
    s_waitcnt lgkmcnt(0)
    v_mfma_f32_16x16x32_bf16 v[20:23], v[80:83], v[84:87], v[20:23]
    ds_read_b128 v[32:35], v11 offset:57792
    ds_read_b64_tr_b16 v[36:37], v12 offset:14336
    ds_read_b64_tr_b16 v[38:39], v12 offset:14592
    ds_read_b128 v[40:43], v11 offset:57856
    ds_read_b64_tr_b16 v[44:45], v12 offset:16384
    ds_read_b64_tr_b16 v[46:47], v12 offset:16640
    ds_read_b128 v[48:51], v11 offset:57920
    ds_read_b64_tr_b16 v[52:53], v12 offset:18432
    ds_read_b64_tr_b16 v[54:55], v12 offset:18688
    ds_read_b128 v[56:59], v11 offset:57984
    ds_read_b64_tr_b16 v[60:61], v12 offset:20480
    ds_read_b64_tr_b16 v[62:63], v12 offset:20736
    ds_read_b128 v[64:67], v11 offset:58048
    ds_read_b64_tr_b16 v[68:69], v12 offset:22528
    ds_read_b64_tr_b16 v[70:71], v12 offset:22784
    ds_read_b128 v[72:75], v11 offset:58112
    ds_read_b64_tr_b16 v[76:77], v12 offset:24576
    ds_read_b64_tr_b16 v[78:79], v12 offset:24832
    ds_read_b128 v[80:83], v11 offset:58176
    ds_read_b64_tr_b16 v[84:85], v12 offset:26624
    ds_read_b64_tr_b16 v[86:87], v12 offset:26880
    s_waitcnt lgkmcnt(15)
    v_mfma_f32_16x16x32_bf16 v[20:23], v[32:35], v[36:39], v[20:23]
    s_waitcnt lgkmcnt(15)
    v_mfma_f32_16x16x32_bf16 v[20:23], v[40:43], v[44:47], v[20:23]
    s_waitcnt lgkmcnt(12)
    v_mfma_f32_16x16x32_bf16 v[20:23], v[48:51], v[52:55], v[20:23]
    s_waitcnt lgkmcnt(9)
    v_mfma_f32_16x16x32_bf16 v[20:23], v[56:59], v[60:63], v[20:23]
    s_waitcnt lgkmcnt(6)
    v_mfma_f32_16x16x32_bf16 v[20:23], v[64:67], v[68:71], v[20:23]
    s_waitcnt lgkmcnt(3)
    v_mfma_f32_16x16x32_bf16 v[20:23], v[72:75], v[76:79], v[20:23]
    s_waitcnt lgkmcnt(0)
    v_mfma_f32_16x16x32_bf16 v[20:23], v[80:83], v[84:87], v[20:23]
    s_nop 7
    v_cvt_pk_bf16_f32 v20, v20, v20
    v_lshlrev_b32 v20, 16, v20
    v_cvt_pk_bf16_f32 v21, v21, v21
    v_lshlrev_b32 v21, 16, v21
    v_cmp_eq_u32 vcc, 0, v4
    s_and_saveexec_b64 s[48:49], vcc
    s_lshl_b32 s50, s34, 6
    v_lshl_add_u32 v13, v3, 2, s50
    ds_write_b32 v13, v20 offset:59136
    ds_write_b32 v13, v21 offset:59392
    s_mov_b64 exec, s[48:49]
K2_mnogu:
    s_waitcnt lgkmcnt(0)
    s_barrier
    ds_write_b128 v112, v[96:99]
    ds_write_b128 v113, v[100:103]
    ds_write_b128 v114, v[104:107]
    s_cmp_ge_u32 s34, 4
    s_cbranch_scc1 K2_mnd3
    ds_write_b128 v115, v[108:111]
K2_mnd3:
    v_cmp_gt_u32 vcc, 64, v0
    s_and_saveexec_b64 s[48:49], vcc
    s_cbranch_execz K2_moe_r2
    v_lshrrev_b32 v12, 5, v0
    v_lshlrev_b32 v12, 8, v12
    v_and_b32 v13, 31, v0
    v_lshl_add_u32 v13, v13, 2, v12
    ds_read_b32 v12, v13 offset:59136
    ds_read_b32 v14, v13 offset:59264
    s_waitcnt lgkmcnt(0)
    v_mul_f32 v15, 0xbfb8aa3b, v12
    v_exp_f32 v15, v15
    s_nop 0
    v_add_f32 v15, 1.0, v15
    v_rcp_f32 v15, v15
    s_nop 0
    v_mul_f32 v12, v12, v15
    v_cvt_pk_bf16_f32 v12, v12, v12
    v_lshlrev_b32 v12, 16, v12
    v_mul_f32 v12, v12, v14
    v_cvt_pk_bf16_f32 v12, v12, v12
    v_lshlrev_b32 v13, 1, v0
    ds_write_b16 v13, v12 offset:59648
K2_moe_r2:
    s_mov_b64 exec, s[48:49]
    s_waitcnt lgkmcnt(0)
    s_barrier
    v_and_b32 v11, 1, v3
    v_lshlrev_b32 v11, 6, v11
    v_lshl_add_u32 v11, v4, 4, v11
    ds_read_b128 v[64:67], v11 offset:59648
    v_lshrrev_b32 v12, 2, v3
    v_lshl_add_u32 v12, v4, 3, v12
    v_mul_u32_u24 v12, 896, v12
    v_and_b32 v13, 3, v3
    v_lshl_add_u32 v12, v13, 3, v12
    s_lshl_b32 s50, s34, 5
    v_add_u32 v12, s50, v12
    s_mul_i32 s51, s2, 3584
    s_add_u32 s51, s51, 8159232
    s_lshl_b32 s52, s34, 6
    s_add_u32 s51, s51, s52
    v_lshl_add_u32 v14, v3, 2, s51
    v_cmp_eq_u32 s[52:53], 0, v4
    ds_read_b64_tr_b16 v[68:69], v12 offset:0
    ds_read_b64_tr_b16 v[70:71], v12 offset:3584
    s_waitcnt lgkmcnt(0)
    v_mfma_f32_16x16x32_bf16 v[20:23], v[64:67], v[68:71], 0
    s_nop 7
    s_mov_b64 s[48:49], exec
    s_mov_b64 exec, s[52:53]
    buffer_store_dword v20, v14, s[24:27], 0 offen offset:0
    buffer_store_dword v21, v14, s[24:27], 0 offen offset:1792
    s_mov_b64 exec, s[48:49]
    ds_read_b64_tr_b16 v[68:69], v12 offset:256
    ds_read_b64_tr_b16 v[70:71], v12 offset:3840
    s_waitcnt lgkmcnt(0)
    v_mfma_f32_16x16x32_bf16 v[20:23], v[64:67], v[68:71], 0
    s_nop 7
    s_mov_b64 s[48:49], exec
    s_mov_b64 exec, s[52:53]
    buffer_store_dword v20, v14, s[24:27], 0 offen offset:512
    buffer_store_dword v21, v14, s[24:27], 0 offen offset:2304
    s_mov_b64 exec, s[48:49]
    ds_read_b64_tr_b16 v[68:69], v12 offset:512
    ds_read_b64_tr_b16 v[70:71], v12 offset:4096
    s_waitcnt lgkmcnt(0)
    v_mfma_f32_16x16x32_bf16 v[20:23], v[64:67], v[68:71], 0
    s_nop 7
    s_mov_b64 s[48:49], exec
    s_mov_b64 exec, s[52:53]
    buffer_store_dword v20, v14, s[24:27], 0 offen offset:1024
    buffer_store_dword v21, v14, s[24:27], 0 offen offset:2816
    s_mov_b64 exec, s[48:49]
    s_cmp_ge_u32 s34, 4
    s_cbranch_scc1 K2_mnt3
    ds_read_b64_tr_b16 v[68:69], v12 offset:768
    ds_read_b64_tr_b16 v[70:71], v12 offset:4352
    s_waitcnt lgkmcnt(0)
    v_mfma_f32_16x16x32_bf16 v[20:23], v[64:67], v[68:71], 0
    s_nop 7
    s_mov_b64 s[48:49], exec
    s_mov_b64 exec, s[52:53]
    buffer_store_dword v20, v14, s[24:27], 0 offen offset:1536
    buffer_store_dword v21, v14, s[24:27], 0 offen offset:3328
    s_mov_b64 exec, s[48:49]
K2_mnt3:
    s_cmp_lg_u32 s2, 0
    s_cbranch_scc1 K2_done
    v_cmp_eq_u32 vcc, 0, v0
    s_and_saveexec_b64 s[48:49], vcc
    v_mov_b32 v12, s43
    v_mov_b32 v13, s44
    v_mov_b32 v14, s45
    v_mul_f32 v14, 0xbfb8aa3b, v14
    v_exp_f32 v14, v14
    s_nop 0
    v_add_f32 v14, 1.0, v14
    v_rcp_f32 v14, v14
    s_nop 0
    v_cvt_pk_bf16_f32 v14, v14, v14
    v_lshlrev_b32 v14, 16, v14
    v_mov_b32 v15, s46
    v_mul_f32 v15, 0xbfb8aa3b, v15
    v_exp_f32 v15, v15
    s_nop 0
    v_add_f32 v15, 1.0, v15
    v_rcp_f32 v15, v15
    s_nop 0
    v_cvt_pk_bf16_f32 v15, v15, v15
    v_lshlrev_b32 v15, 16, v15
    v_mov_b32 v11, 8151040
    buffer_store_dwordx4 v[12:15], v11, s[24:27], 0 offen
K2_done:
    s_endpgm
.globl k3_kernel
.p2align 8
.type k3_kernel,@function
k3_kernel:
    s_cmp_ge_u32 s2, 224
    s_cbranch_scc1 K3_done
    s_load_dwordx2 s[4:5], s[0:1], 0
    s_load_dwordx2 s[6:7], s[0:1], 16
    s_load_dwordx2 s[8:9], s[0:1], 64
    s_load_dwordx2 s[10:11], s[0:1], 80
    s_and_b32 s12, s2, 31
    s_lshr_b32 s13, s2, 5
    v_and_b32 v1, 63, v0
    v_lshrrev_b32 v2, 6, v0
    v_and_b32 v3, 15, v0
    v_bfe_u32 v4, v0, 4, 2
    v_readfirstlane_b32 s34, v2
    s_waitcnt lgkmcnt(0)
    s_add_u32 s14, s10, 8151040
    s_addc_u32 s15, s11, 0
    s_load_dwordx4 s[40:43], s[14:15], 0
    s_mov_b32 s16, s4
    s_and_b32 s17, s5, 0xffff
    s_mov_b32 s18, 1835008
    s_mov_b32 s19, 0x00020000
    s_mov_b32 s20, s6
    s_and_b32 s21, s7, 0xffff
    s_mov_b32 s22, 401408
    s_mov_b32 s23, 0x00020000
    s_mov_b32 s24, s10
    s_and_b32 s25, s11, 0xffff
    s_mov_b32 s26, 8388608
    s_mov_b32 s27, 0x00020000
    s_mov_b32 s28, s8
    s_and_b32 s29, s9, 0xffff
    s_mov_b32 s30, 1835008
    s_mov_b32 s31, 0x00020000
    s_lshl_b32 s32, s12, 6
    s_lshl_b32 s33, s13, 7
    v_lshrrev_b32 v6, 3, v1
    v_and_b32 v7, 7, v1
    v_xor_b32 v7, v7, v6
    v_lshl_add_u32 v6, v2, 3, v6
    v_add_u32 v6, s32, v6
    v_mul_u32_u24 v6, 896, v6
    v_lshl_add_u32 v6, v7, 4, v6
    v_add_u32 v6, 6291456, v6
    v_lshrrev_b32 v7, 3, v1
    v_bfe_u32 v8, v1, 4, 1
    v_and_b32 v9, 1, v2
    v_lshl_add_u32 v8, v9, 1, v8
    v_bfe_u32 v9, v1, 1, 2
    v_xor_b32 v9, v9, v8
    v_lshl_add_u32 v7, v2, 3, v7
    v_mul_u32_u24 v7, 896, v7
    v_lshl_add_u32 v7, v9, 5, v7
    v_and_b32 v8, 1, v1
    v_lshl_add_u32 v7, v8, 4, v7
    v_add_u32 v7, s33, v7
    s_lshl_b32 s35, s34, 10
    s_mov_b32 s36, 0
    s_add_u32 s37, s35, 512
    s_mov_b32 m0, s37
    s_nop 0
    buffer_load_dwordx4 v6, s[24:27], s36 offen lds
    s_mov_b32 s36, 0
    s_add_u32 s37, s35, 57856
    s_mov_b32 m0, s37
    s_nop 0
    buffer_load_dwordx4 v7, s[20:23], s36 offen lds
    s_mov_b32 s36, 128
    s_add_u32 s37, s35, 8704
    s_mov_b32 m0, s37
    s_nop 0
    buffer_load_dwordx4 v6, s[24:27], s36 offen lds
    s_mov_b32 s36, 57344
    s_add_u32 s37, s35, 66048
    s_mov_b32 m0, s37
    s_nop 0
    buffer_load_dwordx4 v7, s[20:23], s36 offen lds
    s_mov_b32 s36, 256
    s_add_u32 s37, s35, 16896
    s_mov_b32 m0, s37
    s_nop 0
    buffer_load_dwordx4 v6, s[24:27], s36 offen lds
    s_mov_b32 s36, 114688
    s_add_u32 s37, s35, 74240
    s_mov_b32 m0, s37
    s_nop 0
    buffer_load_dwordx4 v7, s[20:23], s36 offen lds
    s_mov_b32 s36, 384
    s_add_u32 s37, s35, 25088
    s_mov_b32 m0, s37
    s_nop 0
    buffer_load_dwordx4 v6, s[24:27], s36 offen lds
    s_mov_b32 s36, 172032
    s_add_u32 s37, s35, 82432
    s_mov_b32 m0, s37
    s_nop 0
    buffer_load_dwordx4 v7, s[20:23], s36 offen lds
    s_mov_b32 s36, 512
    s_add_u32 s37, s35, 33280
    s_mov_b32 m0, s37
    s_nop 0
    buffer_load_dwordx4 v6, s[24:27], s36 offen lds
    s_mov_b32 s36, 229376
    s_add_u32 s37, s35, 90624
    s_mov_b32 m0, s37
    s_nop 0
    buffer_load_dwordx4 v7, s[20:23], s36 offen lds
    s_mov_b32 s36, 640
    s_add_u32 s37, s35, 41472
    s_mov_b32 m0, s37
    s_nop 0
    buffer_load_dwordx4 v6, s[24:27], s36 offen lds
    s_mov_b32 s36, 286720
    s_add_u32 s37, s35, 98816
    s_mov_b32 m0, s37
    s_nop 0
    buffer_load_dwordx4 v7, s[20:23], s36 offen lds
    s_mov_b32 s36, 768
    s_add_u32 s37, s35, 49664
    s_mov_b32 m0, s37
    s_nop 0
    buffer_load_dwordx4 v6, s[24:27], s36 offen lds
    s_mov_b32 s36, 344064
    s_add_u32 s37, s35, 107008
    s_mov_b32 m0, s37
    s_nop 0
    buffer_load_dwordx4 v7, s[20:23], s36 offen lds
    v_and_b32 v5, 3, v2
    v_lshl_add_u32 v5, v5, 4, v3
    v_add_u32 v11, s32, v5
    v_mul_u32_u24 v12, 896, v11
    v_lshl_add_u32 v12, v4, 3, v12
    v_add_u32 v12, s33, v12
    v_lshrrev_b32 v13, 2, v2
    v_lshl_add_u32 v12, v13, 6, v12
    buffer_load_dwordx2 v[200:201], v12, s[16:19], 0 offen offset:0
    buffer_load_dwordx2 v[202:203], v12, s[16:19], 0 offen offset:32
    v_lshlrev_b32 v14, 3, v11
    v_add_u32 v14, 8126464, v14
    buffer_load_dwordx2 v[208:209], v14, s[24:27], 0 offen
    s_waitcnt lgkmcnt(0)
    s_cmp_gt_u32 s34, 1
    s_cbranch_scc1 K3_noy
    s_cmp_eq_u32 s34, 0
    s_cselect_b32 s35, s40, s41
    s_cselect_b32 s36, s42, s43
    s_lshr_b32 s37, s35, 6
    s_cmp_lg_u32 s37, s12
    s_cbranch_scc1 K3_noy
    s_mul_i32 s38, s34, 1792
    s_lshl_b32 s39, s13, 8
    s_add_u32 s38, s38, s39
    s_add_u32 s38, s38, 8159232
    v_lshlrev_b32 v14, 2, v1
    v_add_u32 v14, s38, v14
    v_mov_b32 v15, 0
    buffer_load_dword v64, v14, s[24:27], 0 offen
    v_add_u32 v14, 3584, v14
    buffer_load_dword v65, v14, s[24:27], 0 offen
    v_add_u32 v14, 3584, v14
    buffer_load_dword v66, v14, s[24:27], 0 offen
    v_add_u32 v14, 3584, v14
    buffer_load_dword v67, v14, s[24:27], 0 offen
    v_add_u32 v14, 3584, v14
    buffer_load_dword v68, v14, s[24:27], 0 offen
    v_add_u32 v14, 3584, v14
    buffer_load_dword v69, v14, s[24:27], 0 offen
    v_add_u32 v14, 3584, v14
    buffer_load_dword v70, v14, s[24:27], 0 offen
    v_add_u32 v14, 3584, v14
    buffer_load_dword v71, v14, s[24:27], 0 offen
    v_add_u32 v14, 3584, v14
    buffer_load_dword v72, v14, s[24:27], 0 offen
    v_add_u32 v14, 3584, v14
    buffer_load_dword v73, v14, s[24:27], 0 offen
    v_add_u32 v14, 3584, v14
    buffer_load_dword v74, v14, s[24:27], 0 offen
    v_add_u32 v14, 3584, v14
    buffer_load_dword v75, v14, s[24:27], 0 offen
    v_add_u32 v14, 3584, v14
    buffer_load_dword v76, v14, s[24:27], 0 offen
    v_add_u32 v14, 3584, v14
    buffer_load_dword v77, v14, s[24:27], 0 offen
    v_add_u32 v14, 3584, v14
    buffer_load_dword v78, v14, s[24:27], 0 offen
    v_add_u32 v14, 3584, v14
    buffer_load_dword v79, v14, s[24:27], 0 offen
    v_add_u32 v14, 3584, v14
    buffer_load_dword v80, v14, s[24:27], 0 offen
    v_add_u32 v14, 3584, v14
    buffer_load_dword v81, v14, s[24:27], 0 offen
    v_add_u32 v14, 3584, v14
    buffer_load_dword v82, v14, s[24:27], 0 offen
    v_add_u32 v14, 3584, v14
    buffer_load_dword v83, v14, s[24:27], 0 offen
    v_add_u32 v14, 3584, v14
    buffer_load_dword v84, v14, s[24:27], 0 offen
    v_add_u32 v14, 3584, v14
    buffer_load_dword v85, v14, s[24:27], 0 offen
    v_add_u32 v14, 3584, v14
    buffer_load_dword v86, v14, s[24:27], 0 offen
    v_add_u32 v14, 3584, v14
    buffer_load_dword v87, v14, s[24:27], 0 offen
    v_add_u32 v14, 3584, v14
    buffer_load_dword v88, v14, s[24:27], 0 offen
    v_add_u32 v14, 3584, v14
    buffer_load_dword v89, v14, s[24:27], 0 offen
    v_add_u32 v14, 3584, v14
    buffer_load_dword v90, v14, s[24:27], 0 offen
    v_add_u32 v14, 3584, v14
    buffer_load_dword v91, v14, s[24:27], 0 offen
    v_add_u32 v14, 3584, v14
    buffer_load_dword v92, v14, s[24:27], 0 offen
    v_add_u32 v14, 3584, v14
    buffer_load_dword v93, v14, s[24:27], 0 offen
    v_add_u32 v14, 3584, v14
    buffer_load_dword v94, v14, s[24:27], 0 offen
    v_add_u32 v14, 3584, v14
    buffer_load_dword v95, v14, s[24:27], 0 offen
    v_add_u32 v14, 3584, v14
    buffer_load_dword v96, v14, s[24:27], 0 offen
    v_add_u32 v14, 3584, v14
    buffer_load_dword v97, v14, s[24:27], 0 offen
    v_add_u32 v14, 3584, v14
    buffer_load_dword v98, v14, s[24:27], 0 offen
    v_add_u32 v14, 3584, v14
    buffer_load_dword v99, v14, s[24:27], 0 offen
    v_add_u32 v14, 3584, v14
    buffer_load_dword v100, v14, s[24:27], 0 offen
    v_add_u32 v14, 3584, v14
    buffer_load_dword v101, v14, s[24:27], 0 offen
    v_add_u32 v14, 3584, v14
    buffer_load_dword v102, v14, s[24:27], 0 offen
    v_add_u32 v14, 3584, v14
    buffer_load_dword v103, v14, s[24:27], 0 offen
    v_add_u32 v14, 3584, v14
    buffer_load_dword v104, v14, s[24:27], 0 offen
    v_add_u32 v14, 3584, v14
    buffer_load_dword v105, v14, s[24:27], 0 offen
    v_add_u32 v14, 3584, v14
    buffer_load_dword v106, v14, s[24:27], 0 offen
    v_add_u32 v14, 3584, v14
    buffer_load_dword v107, v14, s[24:27], 0 offen
    v_add_u32 v14, 3584, v14
    buffer_load_dword v108, v14, s[24:27], 0 offen
    v_add_u32 v14, 3584, v14
    buffer_load_dword v109, v14, s[24:27], 0 offen
    v_add_u32 v14, 3584, v14
    buffer_load_dword v110, v14, s[24:27], 0 offen
    v_add_u32 v14, 3584, v14
    buffer_load_dword v111, v14, s[24:27], 0 offen
    v_add_u32 v14, 3584, v14
    buffer_load_dword v112, v14, s[24:27], 0 offen
    v_add_u32 v14, 3584, v14
    buffer_load_dword v113, v14, s[24:27], 0 offen
    v_add_u32 v14, 3584, v14
    buffer_load_dword v114, v14, s[24:27], 0 offen
    v_add_u32 v14, 3584, v14
    buffer_load_dword v115, v14, s[24:27], 0 offen
    v_add_u32 v14, 3584, v14
    buffer_load_dword v116, v14, s[24:27], 0 offen
    v_add_u32 v14, 3584, v14
    buffer_load_dword v117, v14, s[24:27], 0 offen
    v_add_u32 v14, 3584, v14
    buffer_load_dword v118, v14, s[24:27], 0 offen
    v_add_u32 v14, 3584, v14
    buffer_load_dword v119, v14, s[24:27], 0 offen
    v_add_u32 v14, 3584, v14
    s_waitcnt vmcnt(0)
    v_add_f32 v15, v15, v64
    v_add_f32 v15, v15, v65
    v_add_f32 v15, v15, v66
    v_add_f32 v15, v15, v67
    v_add_f32 v15, v15, v68
    v_add_f32 v15, v15, v69
    v_add_f32 v15, v15, v70
    v_add_f32 v15, v15, v71
    v_add_f32 v15, v15, v72
    v_add_f32 v15, v15, v73
    v_add_f32 v15, v15, v74
    v_add_f32 v15, v15, v75
    v_add_f32 v15, v15, v76
    v_add_f32 v15, v15, v77
    v_add_f32 v15, v15, v78
    v_add_f32 v15, v15, v79
    v_add_f32 v15, v15, v80
    v_add_f32 v15, v15, v81
    v_add_f32 v15, v15, v82
    v_add_f32 v15, v15, v83
    v_add_f32 v15, v15, v84
    v_add_f32 v15, v15, v85
    v_add_f32 v15, v15, v86
    v_add_f32 v15, v15, v87
    v_add_f32 v15, v15, v88
    v_add_f32 v15, v15, v89
    v_add_f32 v15, v15, v90
    v_add_f32 v15, v15, v91
    v_add_f32 v15, v15, v92
    v_add_f32 v15, v15, v93
    v_add_f32 v15, v15, v94
    v_add_f32 v15, v15, v95
    v_add_f32 v15, v15, v96
    v_add_f32 v15, v15, v97
    v_add_f32 v15, v15, v98
    v_add_f32 v15, v15, v99
    v_add_f32 v15, v15, v100
    v_add_f32 v15, v15, v101
    v_add_f32 v15, v15, v102
    v_add_f32 v15, v15, v103
    v_add_f32 v15, v15, v104
    v_add_f32 v15, v15, v105
    v_add_f32 v15, v15, v106
    v_add_f32 v15, v15, v107
    v_add_f32 v15, v15, v108
    v_add_f32 v15, v15, v109
    v_add_f32 v15, v15, v110
    v_add_f32 v15, v15, v111
    v_add_f32 v15, v15, v112
    v_add_f32 v15, v15, v113
    v_add_f32 v15, v15, v114
    v_add_f32 v15, v15, v115
    v_add_f32 v15, v15, v116
    v_add_f32 v15, v15, v117
    v_add_f32 v15, v15, v118
    v_add_f32 v15, v15, v119
    v_cvt_pk_bf16_f32 v15, v15, v15
    v_lshlrev_b32 v15, 16, v15
    v_mul_f32 v15, s36, v15
    v_cvt_pk_bf16_f32 v15, v15, v15
    v_lshlrev_b32 v15, 16, v15
    v_lshlrev_b32 v14, 2, v1
    s_lshl_b32 s39, s34, 8
    v_add_u32 v14, s39, v14
    ds_write_b32 v14, v15
K3_noy:
    v_and_b32 v8, 7, v3
    v_xor_b32 v8, v8, v4
    v_lshlrev_b32 v8, 4, v8
    v_lshl_add_u32 v8, v5, 7, v8
    v_add_u32 v8, 512, v8
    v_xor_b32 v9, 64, v8
    v_lshrrev_b32 v10, 2, v3
    v_bfe_u32 v15, v3, 3, 1
    v_and_b32 v16, 1, v4
    v_lshl_add_u32 v15, v16, 1, v15
    v_lshl_add_u32 v10, v4, 3, v10
    v_lshlrev_b32 v10, 7, v10
    v_and_b32 v16, 3, v3
    v_lshl_add_u32 v10, v16, 3, v10
    v_add_u32 v10, 57856, v10
    v_lshlrev_b32 v17, 1, v13
    v_add_u32 v16, 0, v17
    v_xor_b32 v16, v16, v15
    v_lshl_add_u32 v40, v16, 5, v10
    v_add_u32 v16, 1, v17
    v_xor_b32 v16, v16, v15
    v_lshl_add_u32 v41, v16, 5, v10
    v_mov_b32 v212, 0
    v_mov_b32 v213, 0
    v_mov_b32 v214, 0
    v_mov_b32 v215, 0
    v_mov_b32 v216, 0
    v_mov_b32 v217, 0
    v_mov_b32 v218, 0
    v_mov_b32 v219, 0
    s_waitcnt vmcnt(0) lgkmcnt(0)
    s_barrier
    ds_read_b128 v[64:67], v8 offset:0
    ds_read_b64_tr_b16 v[128:129], v40 offset:0
    ds_read_b64_tr_b16 v[130:131], v40 offset:512
    ds_read_b64_tr_b16 v[132:133], v41 offset:0
    ds_read_b64_tr_b16 v[134:135], v41 offset:512
    ds_read_b128 v[68:71], v9 offset:0
    ds_read_b64_tr_b16 v[136:137], v40 offset:4096
    ds_read_b64_tr_b16 v[138:139], v40 offset:4608
    ds_read_b64_tr_b16 v[140:141], v41 offset:4096
    ds_read_b64_tr_b16 v[142:143], v41 offset:4608
    ds_read_b128 v[72:75], v8 offset:8192
    ds_read_b64_tr_b16 v[144:145], v40 offset:8192
    ds_read_b64_tr_b16 v[146:147], v40 offset:8704
    ds_read_b64_tr_b16 v[148:149], v41 offset:8192
    ds_read_b64_tr_b16 v[150:151], v41 offset:8704
    ds_read_b128 v[76:79], v9 offset:8192
    ds_read_b64_tr_b16 v[152:153], v40 offset:12288
    ds_read_b64_tr_b16 v[154:155], v40 offset:12800
    ds_read_b64_tr_b16 v[156:157], v41 offset:12288
    ds_read_b64_tr_b16 v[158:159], v41 offset:12800
    ds_read_b128 v[80:83], v8 offset:16384
    ds_read_b64_tr_b16 v[160:161], v40 offset:16384
    ds_read_b64_tr_b16 v[162:163], v40 offset:16896
    ds_read_b64_tr_b16 v[164:165], v41 offset:16384
    ds_read_b64_tr_b16 v[166:167], v41 offset:16896
    ds_read_b128 v[84:87], v9 offset:16384
    ds_read_b64_tr_b16 v[168:169], v40 offset:20480
    ds_read_b64_tr_b16 v[170:171], v40 offset:20992
    ds_read_b64_tr_b16 v[172:173], v41 offset:20480
    ds_read_b64_tr_b16 v[174:175], v41 offset:20992
    ds_read_b128 v[88:91], v8 offset:24576
    ds_read_b64_tr_b16 v[176:177], v40 offset:24576
    ds_read_b64_tr_b16 v[178:179], v40 offset:25088
    ds_read_b64_tr_b16 v[180:181], v41 offset:24576
    ds_read_b64_tr_b16 v[182:183], v41 offset:25088
    s_waitcnt lgkmcnt(15)
    v_mfma_f32_16x16x32_bf16 v[212:215], v[128:131], v[64:67], v[212:215]
    v_mfma_f32_16x16x32_bf16 v[216:219], v[132:135], v[64:67], v[216:219]
    s_waitcnt lgkmcnt(15)
    v_mfma_f32_16x16x32_bf16 v[212:215], v[136:139], v[68:71], v[212:215]
    v_mfma_f32_16x16x32_bf16 v[216:219], v[140:143], v[68:71], v[216:219]
    s_waitcnt lgkmcnt(15)
    v_mfma_f32_16x16x32_bf16 v[212:215], v[144:147], v[72:75], v[212:215]
    v_mfma_f32_16x16x32_bf16 v[216:219], v[148:151], v[72:75], v[216:219]
    s_waitcnt lgkmcnt(15)
    v_mfma_f32_16x16x32_bf16 v[212:215], v[152:155], v[76:79], v[212:215]
    v_mfma_f32_16x16x32_bf16 v[216:219], v[156:159], v[76:79], v[216:219]
    s_waitcnt lgkmcnt(10)
    v_mfma_f32_16x16x32_bf16 v[212:215], v[160:163], v[80:83], v[212:215]
    v_mfma_f32_16x16x32_bf16 v[216:219], v[164:167], v[80:83], v[216:219]
    s_waitcnt lgkmcnt(5)
    v_mfma_f32_16x16x32_bf16 v[212:215], v[168:171], v[84:87], v[212:215]
    v_mfma_f32_16x16x32_bf16 v[216:219], v[172:175], v[84:87], v[216:219]
    s_waitcnt lgkmcnt(0)
    v_mfma_f32_16x16x32_bf16 v[212:215], v[176:179], v[88:91], v[212:215]
    v_mfma_f32_16x16x32_bf16 v[216:219], v[180:183], v[88:91], v[216:219]
    ds_read_b128 v[64:67], v9 offset:24576
    ds_read_b64_tr_b16 v[128:129], v40 offset:28672
    ds_read_b64_tr_b16 v[130:131], v40 offset:29184
    ds_read_b64_tr_b16 v[132:133], v41 offset:28672
    ds_read_b64_tr_b16 v[134:135], v41 offset:29184
    ds_read_b128 v[68:71], v8 offset:32768
    ds_read_b64_tr_b16 v[136:137], v40 offset:32768
    ds_read_b64_tr_b16 v[138:139], v40 offset:33280
    ds_read_b64_tr_b16 v[140:141], v41 offset:32768
    ds_read_b64_tr_b16 v[142:143], v41 offset:33280
    ds_read_b128 v[72:75], v9 offset:32768
    ds_read_b64_tr_b16 v[144:145], v40 offset:36864
    ds_read_b64_tr_b16 v[146:147], v40 offset:37376
    ds_read_b64_tr_b16 v[148:149], v41 offset:36864
    ds_read_b64_tr_b16 v[150:151], v41 offset:37376
    ds_read_b128 v[76:79], v8 offset:40960
    ds_read_b64_tr_b16 v[152:153], v40 offset:40960
    ds_read_b64_tr_b16 v[154:155], v40 offset:41472
    ds_read_b64_tr_b16 v[156:157], v41 offset:40960
    ds_read_b64_tr_b16 v[158:159], v41 offset:41472
    ds_read_b128 v[80:83], v9 offset:40960
    ds_read_b64_tr_b16 v[160:161], v40 offset:45056
    ds_read_b64_tr_b16 v[162:163], v40 offset:45568
    ds_read_b64_tr_b16 v[164:165], v41 offset:45056
    ds_read_b64_tr_b16 v[166:167], v41 offset:45568
    ds_read_b128 v[84:87], v8 offset:49152
    ds_read_b64_tr_b16 v[168:169], v40 offset:49152
    ds_read_b64_tr_b16 v[170:171], v40 offset:49664
    ds_read_b64_tr_b16 v[172:173], v41 offset:49152
    ds_read_b64_tr_b16 v[174:175], v41 offset:49664
    ds_read_b128 v[88:91], v9 offset:49152
    ds_read_b64_tr_b16 v[176:177], v40 offset:53248
    ds_read_b64_tr_b16 v[178:179], v40 offset:53760
    ds_read_b64_tr_b16 v[180:181], v41 offset:53248
    ds_read_b64_tr_b16 v[182:183], v41 offset:53760
    s_waitcnt lgkmcnt(15)
    v_mfma_f32_16x16x32_bf16 v[212:215], v[128:131], v[64:67], v[212:215]
    v_mfma_f32_16x16x32_bf16 v[216:219], v[132:135], v[64:67], v[216:219]
    s_waitcnt lgkmcnt(15)
    v_mfma_f32_16x16x32_bf16 v[212:215], v[136:139], v[68:71], v[212:215]
    v_mfma_f32_16x16x32_bf16 v[216:219], v[140:143], v[68:71], v[216:219]
    s_waitcnt lgkmcnt(15)
    v_mfma_f32_16x16x32_bf16 v[212:215], v[144:147], v[72:75], v[212:215]
    v_mfma_f32_16x16x32_bf16 v[216:219], v[148:151], v[72:75], v[216:219]
    s_waitcnt lgkmcnt(15)
    v_mfma_f32_16x16x32_bf16 v[212:215], v[152:155], v[76:79], v[212:215]
    v_mfma_f32_16x16x32_bf16 v[216:219], v[156:159], v[76:79], v[216:219]
    s_waitcnt lgkmcnt(10)
    v_mfma_f32_16x16x32_bf16 v[212:215], v[160:163], v[80:83], v[212:215]
    v_mfma_f32_16x16x32_bf16 v[216:219], v[164:167], v[80:83], v[216:219]
    s_waitcnt lgkmcnt(5)
    v_mfma_f32_16x16x32_bf16 v[212:215], v[168:171], v[84:87], v[212:215]
    v_mfma_f32_16x16x32_bf16 v[216:219], v[172:175], v[84:87], v[216:219]
    s_waitcnt lgkmcnt(0)
    v_mfma_f32_16x16x32_bf16 v[212:215], v[176:179], v[88:91], v[212:215]
    v_mfma_f32_16x16x32_bf16 v[216:219], v[180:183], v[88:91], v[216:219]
    v_rcp_f32 v46, v209
    v_cmp_eq_u32 s[44:45], s40, v11
    v_cmp_eq_u32 s[46:47], s41, v11
    s_or_b64 s[48:49], s[44:45], s[46:47]
    v_mov_b32 v47, 0
    v_mov_b32 v48, 256
    v_cndmask_b32 v47, v47, v48, s[46:47]
    v_lshl_add_u32 v47, v4, 4, v47
    v_lshl_add_u32 v47, v13, 7, v47
    s_nop 7
    ds_read_b128 v[16:19], v47 offset:0
    ds_read_b128 v[20:23], v47 offset:64
    s_waitcnt lgkmcnt(0)
    v_mov_b32 v49, 0
    v_lshlrev_b32 v50, 16, v200
    v_cvt_pk_bf16_f32 v51, v212, v212
    v_lshlrev_b32 v51, 16, v51
    v_add_f32 v51, v50, v51
    v_cvt_pk_bf16_f32 v51, v51, v51
    v_lshlrev_b32 v51, 16, v51
    v_sub_f32 v52, v50, v208
    v_cvt_pk_bf16_f32 v52, v52, v52
    v_lshlrev_b32 v52, 16, v52
    v_mul_f32 v52, v52, v46
    v_cvt_pk_bf16_f32 v52, v52, v52
    v_lshlrev_b32 v52, 16, v52
    v_cndmask_b32 v53, v49, v16, s[48:49]
    v_add_f32 v52, v52, v53
    v_cvt_pk_bf16_f32 v52, v52, v52
    v_lshlrev_b32 v52, 16, v52
    v_add_f32 v54, v51, v52
    v_and_b32 v50, 0xffff0000, v200
    v_cvt_pk_bf16_f32 v51, v213, v213
    v_lshlrev_b32 v51, 16, v51
    v_add_f32 v51, v50, v51
    v_cvt_pk_bf16_f32 v51, v51, v51
    v_lshlrev_b32 v51, 16, v51
    v_sub_f32 v52, v50, v208
    v_cvt_pk_bf16_f32 v52, v52, v52
    v_lshlrev_b32 v52, 16, v52
    v_mul_f32 v52, v52, v46
    v_cvt_pk_bf16_f32 v52, v52, v52
    v_lshlrev_b32 v52, 16, v52
    v_cndmask_b32 v53, v49, v17, s[48:49]
    v_add_f32 v52, v52, v53
    v_cvt_pk_bf16_f32 v52, v52, v52
    v_lshlrev_b32 v52, 16, v52
    v_add_f32 v55, v51, v52
    v_lshlrev_b32 v50, 16, v201
    v_cvt_pk_bf16_f32 v51, v214, v214
    v_lshlrev_b32 v51, 16, v51
    v_add_f32 v51, v50, v51
    v_cvt_pk_bf16_f32 v51, v51, v51
    v_lshlrev_b32 v51, 16, v51
    v_sub_f32 v52, v50, v208
    v_cvt_pk_bf16_f32 v52, v52, v52
    v_lshlrev_b32 v52, 16, v52
    v_mul_f32 v52, v52, v46
    v_cvt_pk_bf16_f32 v52, v52, v52
    v_lshlrev_b32 v52, 16, v52
    v_cndmask_b32 v53, v49, v18, s[48:49]
    v_add_f32 v52, v52, v53
    v_cvt_pk_bf16_f32 v52, v52, v52
    v_lshlrev_b32 v52, 16, v52
    v_add_f32 v56, v51, v52
    v_and_b32 v50, 0xffff0000, v201
    v_cvt_pk_bf16_f32 v51, v215, v215
    v_lshlrev_b32 v51, 16, v51
    v_add_f32 v51, v50, v51
    v_cvt_pk_bf16_f32 v51, v51, v51
    v_lshlrev_b32 v51, 16, v51
    v_sub_f32 v52, v50, v208
    v_cvt_pk_bf16_f32 v52, v52, v52
    v_lshlrev_b32 v52, 16, v52
    v_mul_f32 v52, v52, v46
    v_cvt_pk_bf16_f32 v52, v52, v52
    v_lshlrev_b32 v52, 16, v52
    v_cndmask_b32 v53, v49, v19, s[48:49]
    v_add_f32 v52, v52, v53
    v_cvt_pk_bf16_f32 v52, v52, v52
    v_lshlrev_b32 v52, 16, v52
    v_add_f32 v57, v51, v52
    v_cvt_pk_bf16_f32 v58, v54, v55
    v_cvt_pk_bf16_f32 v59, v56, v57
    buffer_store_dwordx2 v[58:59], v12, s[28:31], 0 offen offset:0
    s_nop 1
    v_lshlrev_b32 v50, 16, v202
    v_cvt_pk_bf16_f32 v51, v216, v216
    v_lshlrev_b32 v51, 16, v51
    v_add_f32 v51, v50, v51
    v_cvt_pk_bf16_f32 v51, v51, v51
    v_lshlrev_b32 v51, 16, v51
    v_sub_f32 v52, v50, v208
    v_cvt_pk_bf16_f32 v52, v52, v52
    v_lshlrev_b32 v52, 16, v52
    v_mul_f32 v52, v52, v46
    v_cvt_pk_bf16_f32 v52, v52, v52
    v_lshlrev_b32 v52, 16, v52
    v_cndmask_b32 v53, v49, v20, s[48:49]
    v_add_f32 v52, v52, v53
    v_cvt_pk_bf16_f32 v52, v52, v52
    v_lshlrev_b32 v52, 16, v52
    v_add_f32 v54, v51, v52
    v_and_b32 v50, 0xffff0000, v202
    v_cvt_pk_bf16_f32 v51, v217, v217
    v_lshlrev_b32 v51, 16, v51
    v_add_f32 v51, v50, v51
    v_cvt_pk_bf16_f32 v51, v51, v51
    v_lshlrev_b32 v51, 16, v51
    v_sub_f32 v52, v50, v208
    v_cvt_pk_bf16_f32 v52, v52, v52
    v_lshlrev_b32 v52, 16, v52
    v_mul_f32 v52, v52, v46
    v_cvt_pk_bf16_f32 v52, v52, v52
    v_lshlrev_b32 v52, 16, v52
    v_cndmask_b32 v53, v49, v21, s[48:49]
    v_add_f32 v52, v52, v53
    v_cvt_pk_bf16_f32 v52, v52, v52
    v_lshlrev_b32 v52, 16, v52
    v_add_f32 v55, v51, v52
    v_lshlrev_b32 v50, 16, v203
    v_cvt_pk_bf16_f32 v51, v218, v218
    v_lshlrev_b32 v51, 16, v51
    v_add_f32 v51, v50, v51
    v_cvt_pk_bf16_f32 v51, v51, v51
    v_lshlrev_b32 v51, 16, v51
    v_sub_f32 v52, v50, v208
    v_cvt_pk_bf16_f32 v52, v52, v52
    v_lshlrev_b32 v52, 16, v52
    v_mul_f32 v52, v52, v46
    v_cvt_pk_bf16_f32 v52, v52, v52
    v_lshlrev_b32 v52, 16, v52
    v_cndmask_b32 v53, v49, v22, s[48:49]
    v_add_f32 v52, v52, v53
    v_cvt_pk_bf16_f32 v52, v52, v52
    v_lshlrev_b32 v52, 16, v52
    v_add_f32 v56, v51, v52
    v_and_b32 v50, 0xffff0000, v203
    v_cvt_pk_bf16_f32 v51, v219, v219
    v_lshlrev_b32 v51, 16, v51
    v_add_f32 v51, v50, v51
    v_cvt_pk_bf16_f32 v51, v51, v51
    v_lshlrev_b32 v51, 16, v51
    v_sub_f32 v52, v50, v208
    v_cvt_pk_bf16_f32 v52, v52, v52
    v_lshlrev_b32 v52, 16, v52
    v_mul_f32 v52, v52, v46
    v_cvt_pk_bf16_f32 v52, v52, v52
    v_lshlrev_b32 v52, 16, v52
    v_cndmask_b32 v53, v49, v23, s[48:49]
    v_add_f32 v52, v52, v53
    v_cvt_pk_bf16_f32 v52, v52, v52
    v_lshlrev_b32 v52, 16, v52
    v_add_f32 v57, v51, v52
    v_cvt_pk_bf16_f32 v58, v54, v55
    v_cvt_pk_bf16_f32 v59, v56, v57
    buffer_store_dwordx2 v[58:59], v12, s[28:31], 0 offen offset:32
    s_nop 1
K3_done:
    s_endpgm
.section .rodata,"a"
.p2align 6
.amdhsa_kernel k1_kernel
  .amdhsa_next_free_vgpr 256
  .amdhsa_next_free_sgpr 100
  .amdhsa_accum_offset 256
  .amdhsa_group_segment_fixed_size 0
  .amdhsa_kernarg_size 88
  .amdhsa_user_sgpr_count 2
  .amdhsa_user_sgpr_kernarg_segment_ptr 1
  .amdhsa_system_sgpr_workgroup_id_x 1
.end_amdhsa_kernel
.section .rodata,"a"
.p2align 6
.amdhsa_kernel k2_kernel
  .amdhsa_next_free_vgpr 128
  .amdhsa_next_free_sgpr 100
  .amdhsa_accum_offset 128
  .amdhsa_group_segment_fixed_size 0
  .amdhsa_kernarg_size 88
  .amdhsa_user_sgpr_count 2
  .amdhsa_user_sgpr_kernarg_segment_ptr 1
  .amdhsa_system_sgpr_workgroup_id_x 1
.end_amdhsa_kernel
.section .rodata,"a"
.p2align 6
.amdhsa_kernel k3_kernel
  .amdhsa_next_free_vgpr 256
  .amdhsa_next_free_sgpr 100
  .amdhsa_accum_offset 256
  .amdhsa_group_segment_fixed_size 0
  .amdhsa_kernarg_size 88
  .amdhsa_user_sgpr_count 2
  .amdhsa_user_sgpr_kernarg_segment_ptr 1
  .amdhsa_system_sgpr_workgroup_id_x 1
.end_amdhsa_kernel
```
